```python
import torch

def _softmax(x, axis=-1):
    return torch.softmax(x, dim=axis)
def _gelu(x):
    return torch.nn.functional.gelu(x, approximate="tanh")
def _silu(x):
    return torch.nn.functional.silu(x)
def _sigmoid(x):
    return torch.sigmoid(x)
def _layernorm(x, axis=-1, eps=1e-5):
    m = x.mean(dim=axis, keepdim=True)
    v = x.var(dim=axis, keepdim=True, unbiased=False)
    return (x - m) / torch.sqrt(v + eps)
def _scatter_add(tgt, idx, src, axis=0):
    return tgt.clone().index_add_(axis, idx, src)
def _segment_sum(src, seg, n):
    out = torch.zeros((n,) + src.shape[1:], dtype=src.dtype)
    return out.index_add_(0, seg, src)
def _pad(x, pw):
    flat = tuple(v for pair in reversed(pw) for v in pair)
    return torch.nn.functional.pad(x, flat)

kernel_name = 'concat_heads__linear_kernel_hedgehog__linear_kernel_hedgehog__prompt'

def setup_inputs():

    _w = (lambda a: (lambda t: t.to(torch.bfloat16) if t.is_floating_point() else t)(torch.as_tensor(a)))
    def _A_setup():
        B, S, D, H = 1, 2048, 512, 32
        Dh = D // H
        return {
            "x": _w((lambda *s: torch.randn(*s, dtype=torch.bfloat16) * 0.4)(B, S, D)),
            "wqkv": _w((lambda *s: torch.randn(*s, dtype=torch.bfloat16) * 0.4)(D, 3 * D)),
            "w_phi": _w((lambda *s: torch.randn(*s, dtype=torch.bfloat16) * 0.4)(H, Dh, Dh) * (Dh ** -0.5)),
            "wo": _w((lambda *s: torch.randn(*s, dtype=torch.bfloat16) * 0.05)(D, D)),
        }
    _A_in = _A_setup()

    def _B_setup():
        B, S, D, H = 1, 2048, 512, 32
        Dh = D // H
        return {
            "x": _w((lambda *s: torch.randn(*s, dtype=torch.bfloat16) * 0.4)(B, S, D)),
            "wqkv": _w((lambda *s: torch.randn(*s, dtype=torch.bfloat16) * 0.4)(D, 3 * D)),
            "w_phi": _w((lambda *s: torch.randn(*s, dtype=torch.bfloat16) * 0.4)(H, Dh, Dh) * (Dh ** -0.5)),
            "wo": _w((lambda *s: torch.randn(*s, dtype=torch.bfloat16) * 0.05)(D, D)),
        }
    _B_in = _B_setup()

    return {
        "A_x": _A_in["x"],
        "A_wqkv": _A_in["wqkv"],
        "A_w_phi": _A_in["w_phi"],
        "A_wo": _A_in["wo"],
        "B_x": _B_in["x"],
        "B_wqkv": _B_in["wqkv"],
        "B_w_phi": _B_in["w_phi"],
        "B_wo": _B_in["wo"],
    }

def reference(A_x, A_wqkv, A_w_phi, A_wo, B_x, B_wqkv, B_w_phi, B_wo):
    def _A_ref(x, wqkv, w_phi, wo):
        B, S, D = x.shape
        H = 32; Dh = D // H
        qkv = (lambda x, *d: x.permute(*d))((x @ wqkv).reshape(B, S, 3, H, Dh), 2, 0, 3, 1, 4)
        q, k, v = qkv[0], qkv[1], qkv[2]
        pq = torch.einsum("bhsd,hdf->bhsf", q, w_phi)
        pk = torch.einsum("bhsd,hdf->bhsf", k, w_phi)
        phi_q = torch.concatenate([_softmax(pq, axis=-1), _softmax(-pq, axis=-1)], axis=-1)
        phi_k = torch.concatenate([_softmax(pk, axis=-1), _softmax(-pk, axis=-1)], axis=-1)
        kv = torch.einsum("bhsf,bhsd->bhfd", phi_k, v)
        z  = torch.einsum("bhsf->bhf", phi_k)
        num = torch.einsum("bhqf,bhfd->bhqd", phi_q, kv)
        den = torch.einsum("bhqf,bhf->bhq", phi_q, z)[..., None] + 1e-6
        o = num / den
        return (lambda x, *d: x.permute(*d))(o, 0, 2, 1, 3).reshape(B, S, D) @ wo

    def _B_ref(x, wqkv, w_phi, wo):
        B, S, D = x.shape
        H = 32; Dh = D // H
        qkv = (lambda x, *d: x.permute(*d))((x @ wqkv).reshape(B, S, 3, H, Dh), 2, 0, 3, 1, 4)
        q, k, v = qkv[0], qkv[1], qkv[2]
        pq = torch.einsum("bhsd,hdf->bhsf", q, w_phi)
        pk = torch.einsum("bhsd,hdf->bhsf", k, w_phi)
        phi_q = torch.concatenate([_softmax(pq, axis=-1), _softmax(-pq, axis=-1)], axis=-1)
        phi_k = torch.concatenate([_softmax(pk, axis=-1), _softmax(-pk, axis=-1)], axis=-1)
        kv = torch.einsum("bhsf,bhsd->bhfd", phi_k, v)
        z  = torch.einsum("bhsf->bhf", phi_k)
        num = torch.einsum("bhqf,bhfd->bhqd", phi_q, kv)
        den = torch.einsum("bhqf,bhf->bhq", phi_q, z)[..., None] + 1e-6
        o = num / den
        return (lambda x, *d: x.permute(*d))(o, 0, 2, 1, 3).reshape(B, S, D) @ wo

    a = _A_ref(A_x, A_wqkv, A_w_phi, A_wo)
    b = _B_ref(B_x, B_wqkv, B_w_phi, B_wo)
    return torch.concatenate([a, b], axis=-1)
```

```asm
; @launch grid=(256,1,1) block=(512,1,1) lds=163840
.amdgcn_target "amdgcn-amd-amdhsa--gfx950"
.text
.globl concat_heads__linear_kernel_hedgehog__linear_kernel_hedgehog__prompt_kernel
.p2align 8
.type concat_heads__linear_kernel_hedgehog__linear_kernel_hedgehog__prompt_kernel,@function
concat_heads__linear_kernel_hedgehog__linear_kernel_hedgehog__prompt_kernel:
    s_cmp_ge_u32 s2, 256
    s_cbranch_scc1 L_END
    s_load_dwordx16 s[56:71], s[0:1], 0
    s_load_dwordx4 s[72:75], s[0:1], 64
    s_load_dwordx2 s[76:77], s[0:1], 80
    s_and_b32 s42, s2, 7
    s_lshr_b32 s43, s2, 3
    s_lshr_b32 s36, s42, 2
    s_and_b32 s42, s42, 3
    s_lshl_b32 s42, s42, 2
    s_lshr_b32 s44, s43, 3
    s_add_u32 s37, s42, s44
    s_and_b32 s38, s43, 7
    s_lshl_b32 s41, s37, 1
    s_add_u32 s41, s41, s38
    v_lshrrev_b32 v1, 6, v0
    v_and_b32 v2, 63, v0
    v_readfirstlane_b32 s39, v1
    v_lshlrev_b32 v26, 4, v2
    v_lshrrev_b32 v3, 5, v2
    s_and_b32 s40, s39, 3
    s_getpc_b64 s[8:9]
L_PC:
    s_sub_u32 s8, s8, L_PC-concat_heads__linear_kernel_hedgehog__linear_kernel_hedgehog__prompt_kernel
    s_subb_u32 s9, s9, 0
    s_mov_b32 s10, ((L_END-concat_heads__linear_kernel_hedgehog__linear_kernel_hedgehog__prompt_kernel)&0xfffffff0)-16
    s_and_b32 s42, s2, 0x38
    s_add_u32 s42, s42, s39
    s_lshl_b32 s42, s42, 10
    v_add_u32 v8, s42, v26
    v_min_u32 v8, s10, v8
    v_mov_b32 v9, s9
    v_add_co_u32 v8, vcc, s8, v8
    s_nop 1
    v_addc_co_u32 v9, vcc, 0, v9, vcc
    global_load_dwordx4 a[124:127], v[8:9], off
    s_lshl_b32 s48, s40, 11
    s_lshl_b32 s46, s37, 17
    s_lshl_b32 s47, s38, 7
    v_lshrrev_b32 v4, 3, v2
    v_and_b32 v5, 7, v2
    v_lshrrev_b32 v6, 4, v2
    v_xor_b32 v7, v5, v6
    v_lshlrev_b32 v7, 4, v7
    v_lshl_add_u32 v12, v4, 10, v7
    s_lshl_b32 s42, s40, 14
    v_add_u32 v12, s42, v12
    v_xor_b32 v13, 64, v12
    v_add_u32 v13, 7168, v13
    v_and_b32 v7, 1, v6
    v_lshlrev_b32 v7, 2, v7
    v_xor_b32 v7, v5, v7
    v_lshlrev_b32 v27, 4, v7
    v_mul_u32_u24 v14, 3072, v4
    v_add_u32 v14, v14, v27
    s_mul_i32 s43, s40, 49152
    v_add_u32 v14, s43, v14
    v_add_u32 v15, 23552, v14
    s_waitcnt lgkmcnt(0)
    s_cmp_eq_u32 s36, 0
    s_cselect_b32 s8, s56, s64
    s_cselect_b32 s9, s57, s65
    s_mov_b32 s10, 0x200000
    s_mov_b32 s11, 0x00020000
    s_cselect_b32 s12, s58, s66
    s_cselect_b32 s13, s59, s67
    s_mov_b32 s14, 0x180000
    s_mov_b32 s15, 0x00020000
    s_cselect_b32 s16, s60, s68
    s_cselect_b32 s17, s61, s69
    s_mov_b32 s18, 0x4000
    s_mov_b32 s19, 0x00020000
    s_cselect_b32 s20, s62, s70
    s_cselect_b32 s21, s63, s71
    s_mov_b32 s22, 0x80000
    s_mov_b32 s23, 0x00020000
    s_mov_b32 s24, s72
    s_mov_b32 s25, s73
    s_mov_b32 s26, 0x400000
    s_mov_b32 s27, 0x00020000
    s_mov_b32 s32, s74
    s_mov_b32 s33, s75
    s_mov_b32 s34, 0x100
    s_mov_b32 s35, 0x00020000
    s_mov_b32 s28, s76
    s_mov_b32 s29, s77
    s_mov_b32 s30, 0x10000000
    s_mov_b32 s31, 0x00020000
    s_cmp_ge_u32 s39, 4
    s_cbranch_scc1 L_ROLE1
    s_add_u32 s43, s41, 0
    s_and_b32 s43, s43, 7
    s_lshl_b32 s56, s43, 7
    s_add_u32 s56, s56, s46
    s_mul_i32 s64, s43, 196608
    s_add_u32 s64, s64, s47
    s_add_u32 s43, s41, 1
    s_and_b32 s43, s43, 7
    s_lshl_b32 s57, s43, 7
    s_add_u32 s57, s57, s46
    s_mul_i32 s65, s43, 196608
    s_add_u32 s65, s65, s47
    s_add_u32 m0, s48, 0
    s_add_u32 s42, s56, 0
    buffer_load_dwordx4 v12, s[8:11], s42 offen lds
    buffer_load_dwordx4 v13, s[8:11], s42 offen offset:1024 lds
    s_lshl_b32 s42, s40, 9
    s_add_u32 m0, s42, 155648
    s_lshl_b32 s43, s38, 11
    s_add_u32 s42, s42, s43
    s_mov_b32 exec_hi, 0
    buffer_load_dwordx4 v26, s[16:19], s42 offen lds
    s_mov_b32 exec_hi, -1
    s_add_u32 m0, s48, 8192
    s_add_u32 s42, s56, 65536
    buffer_load_dwordx4 v12, s[8:11], s42 offen lds
    buffer_load_dwordx4 v13, s[8:11], s42 offen offset:1024 lds
    s_add_u32 m0, s48, 16384
    s_add_u32 s42, s64, 1024
    buffer_load_dwordx4 v14, s[12:15], s42 offen lds
    buffer_load_dwordx4 v15, s[12:15], s42 offen offset:1024 lds
    s_add_u32 m0, s48, 24576
    s_add_u32 s42, s64, 2048
    buffer_load_dwordx4 v14, s[12:15], s42 offen lds
    buffer_load_dwordx4 v15, s[12:15], s42 offen offset:1024 lds
    s_add_u32 m0, s48, 32768
    s_add_u32 s42, s57, 0
    buffer_load_dwordx4 v12, s[8:11], s42 offen lds
    buffer_load_dwordx4 v13, s[8:11], s42 offen offset:1024 lds
    s_add_u32 m0, s48, 40960
    s_add_u32 s42, s57, 65536
    buffer_load_dwordx4 v12, s[8:11], s42 offen lds
    buffer_load_dwordx4 v13, s[8:11], s42 offen offset:1024 lds
    v_and_b32 v7, 31, v2
    v_bfe_u32 v8, v2, 1, 3
    v_xor_b32 v8, v8, v3
    v_lshlrev_b32 v8, 4, v8
    v_lshl_add_u32 v8, v7, 7, v8
    s_lshl_b32 s44, s40, 12
    v_add_u32 v8, s44, v8
    v_xor_b32 v16, 0, v8
    v_xor_b32 v17, 32, v8
    v_xor_b32 v18, 64, v8
    v_xor_b32 v19, 96, v8
    v_bfe_u32 v7, v2, 2, 2
    v_lshl_add_u32 v8, v3, 3, v7
    v_lshlrev_b32 v8, 7, v8
    v_bfe_u32 v9, v2, 3, 1
    v_lshl_add_u32 v8, v9, 6, v8
    v_bfe_u32 v9, v2, 4, 1
    v_lshl_add_u32 v8, v9, 5, v8
    v_and_b32 v10, 3, v2
    v_lshl_add_u32 v20, v10, 3, v8
    v_xor_b32 v23, 64, v20
    v_add_u32 v21, 0x10000, v20
    v_add_u32 v22, 0x20000, v20
    v_add_u32 v24, 0x10000, v23
    v_add_u32 v25, 0x20000, v23
    v_lshl_add_u32 v8, v3, 2, v7
    v_lshlrev_b32 v8, 5, v8
    v_lshl_add_u32 v8, v9, 4, v8
    v_bfe_u32 v10, v2, 1, 1
    v_lshl_add_u32 v8, v10, 3, v8
    v_and_b32 v10, 1, v2
    v_lshl_add_u32 v8, v10, 9, v8
    v_add_u32 v122, 155648, v8
    s_mov_b32 s50, 0x42700000
    s_mov_b32 s51, 0x3fb8aa3b
    s_lshl_b32 s42, s36, 5
    s_lshl_b32 s43, s38, 2
    s_add_u32 s43, s42, s43
    s_add_u32 s43, s43, s40
    s_lshl_b32 s76, s43, 14
    s_lshl_b32 s77, s43, 11
    s_add_u32 s77, s77, 0x100000
    s_lshl_b32 s42, s36, 6
    s_lshl_b32 s43, s37, 2
    s_add_u32 s43, s42, s43
    s_add_u32 s43, s43, s40
    s_lshl_b32 s49, s43, 15
    s_lshl_b32 s43, s38, 12
    s_add_u32 s49, s49, s43
    s_add_u32 s49, s49, 0x200000
    s_add_u32 s43, s2, 1
    s_and_b32 s43, s43, 3
    s_lshl_b32 s43, s43, 3
    s_lshr_b32 s44, s2, 5
    s_add_u32 s72, s43, s44
    s_bfe_u32 s73, s2, 0x20003
    s_lshl_b32 s74, s73, 1
    s_add_u32 s74, s74, s72
    s_lshl_b32 s43, s72, 1
    s_add_u32 s43, s43, s42
    s_lshl_b32 s75, s43, 15
    s_add_u32 s75, s75, 0x200000
    s_lshl_b32 s42, s37, 10
    s_add_u32 s52, s42, s76
    s_lshl_b32 s42, s37, 7
    s_add_u32 s53, s42, s77
    v_mov_b32 v124, -1
    v_mov_b32 v125, -1
    v_mov_b32 v126, -1
    v_mov_b32 v127, -1
    s_mov_b32 s54, 0
    s_lshl_b32 s42, s36, 4
    s_add_u32 s43, s42, s37
    s_lshl_b32 s43, s43, 3
    s_add_u32 s43, s43, s38
    s_lshl_b32 s43, s43, 5
    s_add_u32 s43, s43, s40
    s_lshl_b32 s3, s43, 2
    s_add_u32 s3, s3, 0x140000
    s_lshr_b32 s43, s72, 1
    s_add_u32 s43, s43, s42
    s_lshl_b32 s4, s43, 10
    s_add_u32 s4, s4, 0x140000
    s_lshl_b32 s44, s40, 12
    v_and_b32 v7, 31, v2
    v_bfe_u32 v8, v2, 1, 2
    v_bfe_u32 v9, v2, 4, 1
    v_lshlrev_b32 v10, 1, v9
    v_xor_b32 v8, v8, v10
    v_lshlrev_b32 v8, 4, v8
    v_lshl_add_u32 v8, v7, 6, v8
    v_lshl_add_u32 v8, v3, 11, v8
    v_add_u32 v119, s44, v8
    v_add_u32 v118, s44, v26
    s_waitcnt vmcnt(10)
    s_barrier
    ds_read_b64_tr_b16 v[76:77], v122 offset:0
    ds_read_b64_tr_b16 v[78:79], v122 offset:256
    ds_read_b64_tr_b16 v[80:81], v122 offset:1024
    ds_read_b64_tr_b16 v[82:83], v122 offset:1280
    v_bfe_u32 v6, v2, 2, 1
    v_cmp_eq_u32 vcc, 0, v6
    s_waitcnt lgkmcnt(3)
    v_lshlrev_b32 v7, 16, v76
    v_and_b32 v8, 0xffff0000, v76
    v_mul_f32 v7, s51, v7
    v_mul_f32 v8, s51, v8
    v_cvt_pk_bf16_f32 v76, v7, v8
    v_lshlrev_b32 v7, 16, v77
    v_and_b32 v8, 0xffff0000, v77
    v_mul_f32 v7, s51, v7
    v_mul_f32 v8, s51, v8
    v_cvt_pk_bf16_f32 v77, v7, v8
    s_waitcnt lgkmcnt(2)
    v_lshlrev_b32 v7, 16, v78
    v_and_b32 v8, 0xffff0000, v78
    v_mul_f32 v7, s51, v7
    v_mul_f32 v8, s51, v8
    v_cvt_pk_bf16_f32 v78, v7, v8
    v_lshlrev_b32 v7, 16, v79
    v_and_b32 v8, 0xffff0000, v79
    v_mul_f32 v7, s51, v7
    v_mul_f32 v8, s51, v8
    v_cvt_pk_bf16_f32 v79, v7, v8
    s_waitcnt lgkmcnt(1)
    v_lshlrev_b32 v7, 16, v80
    v_and_b32 v8, 0xffff0000, v80
    v_mul_f32 v7, s51, v7
    v_mul_f32 v8, s51, v8
    v_cvt_pk_bf16_f32 v80, v7, v8
    v_lshlrev_b32 v7, 16, v81
    v_and_b32 v8, 0xffff0000, v81
    v_mul_f32 v7, s51, v7
    v_mul_f32 v8, s51, v8
    v_cvt_pk_bf16_f32 v81, v7, v8
    s_waitcnt lgkmcnt(0)
    v_lshlrev_b32 v7, 16, v82
    v_and_b32 v8, 0xffff0000, v82
    v_mul_f32 v7, s51, v7
    v_mul_f32 v8, s51, v8
    v_cvt_pk_bf16_f32 v82, v7, v8
    v_lshlrev_b32 v7, 16, v83
    v_and_b32 v8, 0xffff0000, v83
    v_mul_f32 v7, s51, v7
    v_mul_f32 v8, s51, v8
    v_cvt_pk_bf16_f32 v83, v7, v8
    v_cndmask_b32 v28, 0, v76, vcc
    v_cndmask_b32 v32, v76, 0, vcc
    v_cndmask_b32 v29, 0, v77, vcc
    v_cndmask_b32 v33, v77, 0, vcc
    v_cndmask_b32 v30, 0, v78, vcc
    v_cndmask_b32 v34, v78, 0, vcc
    v_cndmask_b32 v31, 0, v79, vcc
    v_cndmask_b32 v35, v79, 0, vcc
    v_cndmask_b32 v36, 0, v80, vcc
    v_cndmask_b32 v40, v80, 0, vcc
    v_cndmask_b32 v37, 0, v81, vcc
    v_cndmask_b32 v41, v81, 0, vcc
    v_cndmask_b32 v38, 0, v82, vcc
    v_cndmask_b32 v42, v82, 0, vcc
    v_cndmask_b32 v39, 0, v83, vcc
    v_cndmask_b32 v43, v83, 0, vcc
    s_add_u32 m0, s48, 49152
    s_add_u32 s42, s65, 1024
    buffer_load_dwordx4 v14, s[12:15], s42 offen lds
    buffer_load_dwordx4 v15, s[12:15], s42 offen offset:1024 lds
    s_add_u32 m0, s48, 57344
    s_add_u32 s42, s65, 2048
    buffer_load_dwordx4 v14, s[12:15], s42 offen lds
    buffer_load_dwordx4 v15, s[12:15], s42 offen offset:1024 lds
    s_add_u32 s43, s41, 2
    s_and_b32 s43, s43, 7
    s_lshl_b32 s58, s43, 7
    s_add_u32 s58, s58, s46
    s_mul_i32 s66, s43, 196608
    s_add_u32 s66, s66, s47
    s_add_u32 s43, s41, 3
    s_and_b32 s43, s43, 7
    s_lshl_b32 s59, s43, 7
    s_add_u32 s59, s59, s46
    s_mul_i32 s67, s43, 196608
    s_add_u32 s67, s67, s47
    s_add_u32 s43, s41, 4
    s_and_b32 s43, s43, 7
    s_lshl_b32 s60, s43, 7
    s_add_u32 s60, s60, s46
    s_mul_i32 s68, s43, 196608
    s_add_u32 s68, s68, s47
    s_add_u32 s43, s41, 5
    s_and_b32 s43, s43, 7
    s_lshl_b32 s61, s43, 7
    s_add_u32 s61, s61, s46
    s_mul_i32 s69, s43, 196608
    s_add_u32 s69, s69, s47
    s_add_u32 s43, s41, 6
    s_and_b32 s43, s43, 7
    s_lshl_b32 s62, s43, 7
    s_add_u32 s62, s62, s46
    s_mul_i32 s70, s43, 196608
    s_add_u32 s70, s70, s47
    s_add_u32 s43, s41, 7
    s_and_b32 s43, s43, 7
    s_lshl_b32 s63, s43, 7
    s_add_u32 s63, s63, s46
    s_mul_i32 s71, s43, 196608
    s_add_u32 s71, s71, s47
    s_waitcnt vmcnt(8)
    s_barrier
    ds_read_b128 a[0:3], v16 offset:0
    ds_read_b64_tr_b16 v[84:85], v20 offset:16384
    ds_read_b64_tr_b16 v[86:87], v20 offset:16896
    s_add_u32 m0, s48, 65536
    s_add_u32 s42, s58, 0
    buffer_load_dwordx4 v12, s[8:11], s42 offen lds
    ds_read_b64_tr_b16 v[88:89], v20 offset:24576
    ds_read_b64_tr_b16 v[90:91], v20 offset:25088
    buffer_load_dwordx4 v13, s[8:11], s42 offen offset:1024 lds
    ds_read_b128 a[4:7], v17 offset:0
    ds_read_b64_tr_b16 v[92:93], v20 offset:18432
    ds_read_b64_tr_b16 v[94:95], v20 offset:18944
    s_add_u32 m0, s48, 73728
    s_add_u32 s42, s58, 65536
    buffer_load_dwordx4 v12, s[8:11], s42 offen lds
    ds_read_b64_tr_b16 v[96:97], v20 offset:26624
    ds_read_b64_tr_b16 v[98:99], v20 offset:27136
    buffer_load_dwordx4 v13, s[8:11], s42 offen offset:1024 lds
    s_waitcnt lgkmcnt(7)
    v_mfma_f32_32x32x16_bf16 v[44:59], v[84:87], a[0:3], 0
    ds_read_b128 a[8:11], v18 offset:0
    ds_read_b64_tr_b16 v[100:101], v20 offset:20480
    ds_read_b64_tr_b16 v[102:103], v20 offset:20992
    s_add_u32 m0, s48, 81920
    s_add_u32 s42, s66, 1024
    buffer_load_dwordx4 v14, s[12:15], s42 offen lds
    s_waitcnt lgkmcnt(8)
    v_mfma_f32_32x32x16_bf16 v[60:75], a[0:3], v[88:91], 0
    ds_read_b64_tr_b16 v[104:105], v20 offset:28672
    ds_read_b64_tr_b16 v[106:107], v20 offset:29184
    buffer_load_dwordx4 v15, s[12:15], s42 offen offset:1024 lds
    s_waitcnt lgkmcnt(7)
    v_mfma_f32_32x32x16_bf16 v[44:59], v[92:95], a[4:7], v[44:59]
    ds_read_b128 a[12:15], v19 offset:0
    ds_read_b64_tr_b16 v[108:109], v20 offset:22528
    ds_read_b64_tr_b16 v[110:111], v20 offset:23040
    s_add_u32 m0, s48, 90112
    s_add_u32 s42, s66, 2048
    buffer_load_dwordx4 v14, s[12:15], s42 offen lds
    s_waitcnt lgkmcnt(8)
    v_mfma_f32_32x32x16_bf16 v[60:75], a[4:7], v[96:99], v[60:75]
    ds_read_b64_tr_b16 v[112:113], v20 offset:30720
    ds_read_b64_tr_b16 v[114:115], v20 offset:31232
    buffer_load_dwordx4 v15, s[12:15], s42 offen offset:1024 lds
    s_waitcnt vmcnt(8)
    s_barrier
    s_waitcnt lgkmcnt(7)
    v_mfma_f32_32x32x16_bf16 v[44:59], v[100:103], a[8:11], v[44:59]
    ds_read_b128 a[16:19], v16 offset:32768
    ds_read_b64_tr_b16 v[84:85], v20 offset:49152
    ds_read_b64_tr_b16 v[86:87], v20 offset:49664
    s_add_u32 m0, s48, 98304
    s_add_u32 s42, s59, 0
    buffer_load_dwordx4 v12, s[8:11], s42 offen lds
    s_waitcnt lgkmcnt(8)
    v_mfma_f32_32x32x16_bf16 v[60:75], a[8:11], v[104:107], v[60:75]
    ds_read_b64_tr_b16 v[88:89], v20 offset:57344
    ds_read_b64_tr_b16 v[90:91], v20 offset:57856
    buffer_load_dwordx4 v13, s[8:11], s42 offen offset:1024 lds
    s_waitcnt lgkmcnt(7)
    v_mfma_f32_32x32x16_bf16 v[44:59], v[108:111], a[12:15], v[44:59]
    ds_read_b128 a[20:23], v17 offset:32768
    ds_read_b64_tr_b16 v[92:93], v20 offset:51200
    ds_read_b64_tr_b16 v[94:95], v20 offset:51712
    s_add_u32 m0, s48, 106496
    s_add_u32 s42, s59, 65536
    buffer_load_dwordx4 v12, s[8:11], s42 offen lds
    s_waitcnt lgkmcnt(8)
    v_mfma_f32_32x32x16_bf16 v[60:75], a[12:15], v[112:115], v[60:75]
    ds_read_b64_tr_b16 v[96:97], v20 offset:59392
    ds_read_b64_tr_b16 v[98:99], v20 offset:59904
    buffer_load_dwordx4 v13, s[8:11], s42 offen offset:1024 lds
    s_waitcnt lgkmcnt(7)
    v_mfma_f32_32x32x16_bf16 v[44:59], v[84:87], a[16:19], v[44:59]
    ds_read_b128 a[24:27], v18 offset:32768
    ds_read_b64_tr_b16 v[100:101], v20 offset:53248
    ds_read_b64_tr_b16 v[102:103], v20 offset:53760
    s_add_u32 m0, s48, 114688
    s_add_u32 s42, s67, 1024
    buffer_load_dwordx4 v14, s[12:15], s42 offen lds
    s_waitcnt lgkmcnt(8)
    v_mfma_f32_32x32x16_bf16 v[60:75], a[16:19], v[88:91], v[60:75]
    ds_read_b64_tr_b16 v[104:105], v20 offset:61440
    ds_read_b64_tr_b16 v[106:107], v20 offset:61952
    buffer_load_dwordx4 v15, s[12:15], s42 offen offset:1024 lds
    s_waitcnt lgkmcnt(7)
    v_mfma_f32_32x32x16_bf16 v[44:59], v[92:95], a[20:23], v[44:59]
    ds_read_b128 a[28:31], v19 offset:32768
    ds_read_b64_tr_b16 v[108:109], v20 offset:55296
    ds_read_b64_tr_b16 v[110:111], v20 offset:55808
    s_add_u32 m0, s48, 122880
    s_add_u32 s42, s67, 2048
    buffer_load_dwordx4 v14, s[12:15], s42 offen lds
    s_waitcnt lgkmcnt(8)
    v_mfma_f32_32x32x16_bf16 v[60:75], a[20:23], v[96:99], v[60:75]
    ds_read_b64_tr_b16 v[112:113], v20 offset:63488
    ds_read_b64_tr_b16 v[114:115], v20 offset:64000
    buffer_load_dwordx4 v15, s[12:15], s42 offen offset:1024 lds
    s_waitcnt vmcnt(8)
    s_barrier
    v_add_u32 v16, 0x10000, v16
    v_add_u32 v17, 0x10000, v17
    v_add_u32 v18, 0x10000, v18
    v_add_u32 v19, 0x10000, v19
    s_waitcnt lgkmcnt(7)
    v_mfma_f32_32x32x16_bf16 v[44:59], v[100:103], a[24:27], v[44:59]
    ds_read_b128 a[32:35], v16 offset:0
    ds_read_b64_tr_b16 v[84:85], v21 offset:16384
    ds_read_b64_tr_b16 v[86:87], v21 offset:16896
    s_add_u32 m0, s48, 131072
    s_add_u32 s42, s60, 0
    buffer_load_dwordx4 v12, s[8:11], s42 offen lds
    s_waitcnt lgkmcnt(8)
    v_mfma_f32_32x32x16_bf16 v[60:75], a[24:27], v[104:107], v[60:75]
    ds_read_b64_tr_b16 v[88:89], v21 offset:24576
    ds_read_b64_tr_b16 v[90:91], v21 offset:25088
    buffer_load_dwordx4 v13, s[8:11], s42 offen offset:1024 lds
    s_waitcnt lgkmcnt(7)
    v_mfma_f32_32x32x16_bf16 v[44:59], v[108:111], a[28:31], v[44:59]
    ds_read_b128 a[36:39], v17 offset:0
    ds_read_b64_tr_b16 v[92:93], v21 offset:18432
    ds_read_b64_tr_b16 v[94:95], v21 offset:18944
    s_add_u32 m0, s48, 139264
    s_add_u32 s42, s60, 65536
    buffer_load_dwordx4 v12, s[8:11], s42 offen lds
    s_waitcnt lgkmcnt(8)
    v_mfma_f32_32x32x16_bf16 v[60:75], a[28:31], v[112:115], v[60:75]
    ds_read_b64_tr_b16 v[96:97], v21 offset:26624
    ds_read_b64_tr_b16 v[98:99], v21 offset:27136
    buffer_load_dwordx4 v13, s[8:11], s42 offen offset:1024 lds
    s_waitcnt lgkmcnt(7)
    v_mfma_f32_32x32x16_bf16 v[44:59], v[84:87], a[32:35], v[44:59]
    ds_read_b128 a[40:43], v18 offset:0
    ds_read_b64_tr_b16 v[100:101], v21 offset:20480
    ds_read_b64_tr_b16 v[102:103], v21 offset:20992
    s_add_u32 m0, s48, 147456
    s_add_u32 s42, s68, 1024
    buffer_load_dwordx4 v14, s[12:15], s42 offen lds
    s_waitcnt lgkmcnt(8)
    v_mfma_f32_32x32x16_bf16 v[60:75], a[32:35], v[88:91], v[60:75]
    ds_read_b64_tr_b16 v[104:105], v21 offset:28672
    ds_read_b64_tr_b16 v[106:107], v21 offset:29184
    buffer_load_dwordx4 v15, s[12:15], s42 offen offset:1024 lds
    s_waitcnt lgkmcnt(7)
    v_mfma_f32_32x32x16_bf16 v[44:59], v[92:95], a[36:39], v[44:59]
    ds_read_b128 a[44:47], v19 offset:0
    ds_read_b64_tr_b16 v[108:109], v21 offset:22528
    ds_read_b64_tr_b16 v[110:111], v21 offset:23040
    s_add_u32 m0, s48, 155648
    s_add_u32 s42, s68, 2048
    buffer_load_dwordx4 v14, s[12:15], s42 offen lds
    s_waitcnt lgkmcnt(8)
    v_mfma_f32_32x32x16_bf16 v[60:75], a[36:39], v[96:99], v[60:75]
    ds_read_b64_tr_b16 v[112:113], v21 offset:30720
    ds_read_b64_tr_b16 v[114:115], v21 offset:31232
    buffer_load_dwordx4 v15, s[12:15], s42 offen offset:1024 lds
    s_waitcnt vmcnt(8)
    s_barrier
    s_waitcnt lgkmcnt(7)
    v_mfma_f32_32x32x16_bf16 v[44:59], v[100:103], a[40:43], v[44:59]
    ds_read_b128 a[48:51], v16 offset:32768
    ds_read_b64_tr_b16 v[84:85], v21 offset:49152
    ds_read_b64_tr_b16 v[86:87], v21 offset:49664
    s_add_u32 m0, s48, 0
    s_add_u32 s42, s61, 0
    buffer_load_dwordx4 v12, s[8:11], s42 offen lds
    s_waitcnt lgkmcnt(8)
    v_mfma_f32_32x32x16_bf16 v[60:75], a[40:43], v[104:107], v[60:75]
    ds_read_b64_tr_b16 v[88:89], v21 offset:57344
    ds_read_b64_tr_b16 v[90:91], v21 offset:57856
    buffer_load_dwordx4 v13, s[8:11], s42 offen offset:1024 lds
    s_waitcnt lgkmcnt(7)
    v_mfma_f32_32x32x16_bf16 v[44:59], v[108:111], a[44:47], v[44:59]
    ds_read_b128 a[52:55], v17 offset:32768
    ds_read_b64_tr_b16 v[92:93], v21 offset:51200
    ds_read_b64_tr_b16 v[94:95], v21 offset:51712
    s_add_u32 m0, s48, 8192
    s_add_u32 s42, s61, 65536
    buffer_load_dwordx4 v12, s[8:11], s42 offen lds
    s_waitcnt lgkmcnt(8)
    v_mfma_f32_32x32x16_bf16 v[60:75], a[44:47], v[112:115], v[60:75]
    ds_read_b64_tr_b16 v[96:97], v21 offset:59392
    ds_read_b64_tr_b16 v[98:99], v21 offset:59904
    buffer_load_dwordx4 v13, s[8:11], s42 offen offset:1024 lds
    s_waitcnt lgkmcnt(7)
    v_mfma_f32_32x32x16_bf16 v[44:59], v[84:87], a[48:51], v[44:59]
    ds_read_b128 a[56:59], v18 offset:32768
    ds_read_b64_tr_b16 v[100:101], v21 offset:53248
    ds_read_b64_tr_b16 v[102:103], v21 offset:53760
    s_add_u32 m0, s48, 16384
    s_add_u32 s42, s69, 1024
    buffer_load_dwordx4 v14, s[12:15], s42 offen lds
    s_waitcnt lgkmcnt(8)
    v_mfma_f32_32x32x16_bf16 v[60:75], a[48:51], v[88:91], v[60:75]
    ds_read_b64_tr_b16 v[104:105], v21 offset:61440
    ds_read_b64_tr_b16 v[106:107], v21 offset:61952
    buffer_load_dwordx4 v15, s[12:15], s42 offen offset:1024 lds
    s_waitcnt lgkmcnt(7)
    v_mfma_f32_32x32x16_bf16 v[44:59], v[92:95], a[52:55], v[44:59]
    ds_read_b128 a[60:63], v19 offset:32768
    ds_read_b64_tr_b16 v[108:109], v21 offset:55296
    ds_read_b64_tr_b16 v[110:111], v21 offset:55808
    s_add_u32 m0, s48, 24576
    s_add_u32 s42, s69, 2048
    buffer_load_dwordx4 v14, s[12:15], s42 offen lds
    s_waitcnt lgkmcnt(8)
    v_mfma_f32_32x32x16_bf16 v[60:75], a[52:55], v[96:99], v[60:75]
    ds_read_b64_tr_b16 v[112:113], v21 offset:63488
    ds_read_b64_tr_b16 v[114:115], v21 offset:64000
    buffer_load_dwordx4 v15, s[12:15], s42 offen offset:1024 lds
    s_waitcnt vmcnt(8)
    s_barrier
    v_add_u32 v16, 0x10000, v16
    v_add_u32 v17, 0x10000, v17
    v_add_u32 v18, 0x10000, v18
    v_add_u32 v19, 0x10000, v19
    s_waitcnt lgkmcnt(7)
    v_mfma_f32_32x32x16_bf16 v[44:59], v[100:103], a[56:59], v[44:59]
    ds_read_b128 a[64:67], v16 offset:0
    ds_read_b64_tr_b16 v[84:85], v22 offset:16384
    ds_read_b64_tr_b16 v[86:87], v22 offset:16896
    s_add_u32 m0, s48, 32768
    s_add_u32 s42, s62, 0
    buffer_load_dwordx4 v12, s[8:11], s42 offen lds
    s_waitcnt lgkmcnt(8)
    v_mfma_f32_32x32x16_bf16 v[60:75], a[56:59], v[104:107], v[60:75]
    ds_read_b64_tr_b16 v[88:89], v22 offset:24576
    ds_read_b64_tr_b16 v[90:91], v22 offset:25088
    buffer_load_dwordx4 v13, s[8:11], s42 offen offset:1024 lds
    s_waitcnt lgkmcnt(7)
    v_mfma_f32_32x32x16_bf16 v[44:59], v[108:111], a[60:63], v[44:59]
    ds_read_b128 a[68:71], v17 offset:0
    ds_read_b64_tr_b16 v[92:93], v22 offset:18432
    ds_read_b64_tr_b16 v[94:95], v22 offset:18944
    s_add_u32 m0, s48, 40960
    s_add_u32 s42, s62, 65536
    buffer_load_dwordx4 v12, s[8:11], s42 offen lds
    s_waitcnt lgkmcnt(8)
    v_mfma_f32_32x32x16_bf16 v[60:75], a[60:63], v[112:115], v[60:75]
    ds_read_b64_tr_b16 v[96:97], v22 offset:26624
    ds_read_b64_tr_b16 v[98:99], v22 offset:27136
    buffer_load_dwordx4 v13, s[8:11], s42 offen offset:1024 lds
    s_waitcnt lgkmcnt(7)
    v_mfma_f32_32x32x16_bf16 v[44:59], v[84:87], a[64:67], v[44:59]
    ds_read_b128 a[72:75], v18 offset:0
    ds_read_b64_tr_b16 v[100:101], v22 offset:20480
    ds_read_b64_tr_b16 v[102:103], v22 offset:20992
    s_add_u32 m0, s48, 49152
    s_add_u32 s42, s70, 1024
    buffer_load_dwordx4 v14, s[12:15], s42 offen lds
    s_waitcnt lgkmcnt(8)
    v_mfma_f32_32x32x16_bf16 v[60:75], a[64:67], v[88:91], v[60:75]
    ds_read_b64_tr_b16 v[104:105], v22 offset:28672
    ds_read_b64_tr_b16 v[106:107], v22 offset:29184
    buffer_load_dwordx4 v15, s[12:15], s42 offen offset:1024 lds
    s_waitcnt lgkmcnt(7)
    v_mfma_f32_32x32x16_bf16 v[44:59], v[92:95], a[68:71], v[44:59]
    ds_read_b128 a[76:79], v19 offset:0
    ds_read_b64_tr_b16 v[108:109], v22 offset:22528
    ds_read_b64_tr_b16 v[110:111], v22 offset:23040
    s_add_u32 m0, s48, 57344
    s_add_u32 s42, s70, 2048
    buffer_load_dwordx4 v14, s[12:15], s42 offen lds
    s_waitcnt lgkmcnt(8)
    v_mfma_f32_32x32x16_bf16 v[60:75], a[68:71], v[96:99], v[60:75]
    ds_read_b64_tr_b16 v[112:113], v22 offset:30720
    ds_read_b64_tr_b16 v[114:115], v22 offset:31232
    buffer_load_dwordx4 v15, s[12:15], s42 offen offset:1024 lds
    s_waitcnt vmcnt(8)
    s_barrier
    v_add_u32 v16, 0xfffe0000, v16
    v_add_u32 v17, 0xfffe0000, v17
    v_add_u32 v18, 0xfffe0000, v18
    v_add_u32 v19, 0xfffe0000, v19
    s_waitcnt lgkmcnt(7)
    v_mfma_f32_32x32x16_bf16 v[44:59], v[100:103], a[72:75], v[44:59]
    ds_read_b128 a[80:83], v16 offset:0
    ds_read_b64_tr_b16 v[84:85], v20 offset:16384
    ds_read_b64_tr_b16 v[86:87], v20 offset:16896
    s_add_u32 m0, s48, 65536
    s_add_u32 s42, s63, 0
    buffer_load_dwordx4 v12, s[8:11], s42 offen lds
    s_waitcnt lgkmcnt(8)
    v_mfma_f32_32x32x16_bf16 v[60:75], a[72:75], v[104:107], v[60:75]
    ds_read_b64_tr_b16 v[88:89], v20 offset:24576
    ds_read_b64_tr_b16 v[90:91], v20 offset:25088
    buffer_load_dwordx4 v13, s[8:11], s42 offen offset:1024 lds
    s_waitcnt lgkmcnt(7)
    v_mfma_f32_32x32x16_bf16 v[44:59], v[108:111], a[76:79], v[44:59]
    ds_read_b128 a[84:87], v17 offset:0
    ds_read_b64_tr_b16 v[92:93], v20 offset:18432
    ds_read_b64_tr_b16 v[94:95], v20 offset:18944
    s_add_u32 m0, s48, 73728
    s_add_u32 s42, s63, 65536
    buffer_load_dwordx4 v12, s[8:11], s42 offen lds
    s_waitcnt lgkmcnt(8)
    v_mfma_f32_32x32x16_bf16 v[60:75], a[76:79], v[112:115], v[60:75]
    ds_read_b64_tr_b16 v[96:97], v20 offset:26624
    ds_read_b64_tr_b16 v[98:99], v20 offset:27136
    buffer_load_dwordx4 v13, s[8:11], s42 offen offset:1024 lds
    s_waitcnt lgkmcnt(7)
    v_mfma_f32_32x32x16_bf16 v[44:59], v[84:87], a[80:83], v[44:59]
    ds_read_b128 a[88:91], v18 offset:0
    ds_read_b64_tr_b16 v[100:101], v20 offset:20480
    ds_read_b64_tr_b16 v[102:103], v20 offset:20992
    s_add_u32 m0, s48, 81920
    s_add_u32 s42, s71, 1024
    buffer_load_dwordx4 v14, s[12:15], s42 offen lds
    s_waitcnt lgkmcnt(8)
    v_mfma_f32_32x32x16_bf16 v[60:75], a[80:83], v[88:91], v[60:75]
    ds_read_b64_tr_b16 v[104:105], v20 offset:28672
    ds_read_b64_tr_b16 v[106:107], v20 offset:29184
    buffer_load_dwordx4 v15, s[12:15], s42 offen offset:1024 lds
    s_waitcnt lgkmcnt(7)
    v_mfma_f32_32x32x16_bf16 v[44:59], v[92:95], a[84:87], v[44:59]
    ds_read_b128 a[92:95], v19 offset:0
    ds_read_b64_tr_b16 v[108:109], v20 offset:22528
    ds_read_b64_tr_b16 v[110:111], v20 offset:23040
    s_add_u32 m0, s48, 90112
    s_add_u32 s42, s71, 2048
    buffer_load_dwordx4 v14, s[12:15], s42 offen lds
    s_waitcnt lgkmcnt(8)
    v_mfma_f32_32x32x16_bf16 v[60:75], a[84:87], v[96:99], v[60:75]
    ds_read_b64_tr_b16 v[112:113], v20 offset:30720
    ds_read_b64_tr_b16 v[114:115], v20 offset:31232
    buffer_load_dwordx4 v15, s[12:15], s42 offen offset:1024 lds
    s_waitcnt vmcnt(8)
    s_barrier
    s_waitcnt lgkmcnt(7)
    v_mfma_f32_32x32x16_bf16 v[44:59], v[100:103], a[88:91], v[44:59]
    ds_read_b128 a[96:99], v16 offset:32768
    ds_read_b64_tr_b16 v[84:85], v20 offset:49152
    ds_read_b64_tr_b16 v[86:87], v20 offset:49664
    s_add_u32 m0, s48, 98304
    s_add_u32 s42, s64, 0
    buffer_load_dwordx4 v14, s[12:15], s42 offen lds
    s_waitcnt lgkmcnt(8)
    v_mfma_f32_32x32x16_bf16 v[60:75], a[88:91], v[104:107], v[60:75]
    ds_read_b64_tr_b16 v[88:89], v20 offset:57344
    ds_read_b64_tr_b16 v[90:91], v20 offset:57856
    buffer_load_dwordx4 v15, s[12:15], s42 offen offset:1024 lds
    s_waitcnt lgkmcnt(7)
    v_mfma_f32_32x32x16_bf16 v[44:59], v[108:111], a[92:95], v[44:59]
    ds_read_b128 a[100:103], v17 offset:32768
    ds_read_b64_tr_b16 v[92:93], v20 offset:51200
    ds_read_b64_tr_b16 v[94:95], v20 offset:51712
    s_add_u32 m0, s48, 106496
    s_add_u32 s42, s65, 0
    buffer_load_dwordx4 v14, s[12:15], s42 offen lds
    s_waitcnt lgkmcnt(8)
    v_mfma_f32_32x32x16_bf16 v[60:75], a[92:95], v[112:115], v[60:75]
    ds_read_b64_tr_b16 v[96:97], v20 offset:59392
    ds_read_b64_tr_b16 v[98:99], v20 offset:59904
    buffer_load_dwordx4 v15, s[12:15], s42 offen offset:1024 lds
    s_waitcnt lgkmcnt(7)
    v_mfma_f32_32x32x16_bf16 v[44:59], v[84:87], a[96:99], v[44:59]
    ds_read_b128 a[104:107], v18 offset:32768
    ds_read_b64_tr_b16 v[100:101], v20 offset:53248
    ds_read_b64_tr_b16 v[102:103], v20 offset:53760
    s_add_u32 m0, s48, 114688
    s_add_u32 s42, s66, 0
    buffer_load_dwordx4 v14, s[12:15], s42 offen lds
    s_waitcnt lgkmcnt(8)
    v_mfma_f32_32x32x16_bf16 v[60:75], a[96:99], v[88:91], v[60:75]
    ds_read_b64_tr_b16 v[104:105], v20 offset:61440
    ds_read_b64_tr_b16 v[106:107], v20 offset:61952
    buffer_load_dwordx4 v15, s[12:15], s42 offen offset:1024 lds
    s_waitcnt lgkmcnt(7)
    v_mfma_f32_32x32x16_bf16 v[44:59], v[92:95], a[100:103], v[44:59]
    ds_read_b128 a[108:111], v19 offset:32768
    ds_read_b64_tr_b16 v[108:109], v20 offset:55296
    ds_read_b64_tr_b16 v[110:111], v20 offset:55808
    s_add_u32 m0, s48, 122880
    s_add_u32 s42, s67, 0
    buffer_load_dwordx4 v14, s[12:15], s42 offen lds
    s_waitcnt lgkmcnt(8)
    v_mfma_f32_32x32x16_bf16 v[60:75], a[100:103], v[96:99], v[60:75]
    ds_read_b64_tr_b16 v[112:113], v20 offset:63488
    ds_read_b64_tr_b16 v[114:115], v20 offset:64000
    buffer_load_dwordx4 v15, s[12:15], s42 offen offset:1024 lds
    s_waitcnt vmcnt(8)
    s_barrier
    v_add_u32 v16, 0x10000, v16
    v_add_u32 v17, 0x10000, v17
    v_add_u32 v18, 0x10000, v18
    v_add_u32 v19, 0x10000, v19
    s_waitcnt lgkmcnt(7)
    v_mfma_f32_32x32x16_bf16 v[44:59], v[100:103], a[104:107], v[44:59]
    ds_read_b128 a[112:115], v16 offset:0
    ds_read_b64_tr_b16 v[84:85], v21 offset:16384
    ds_read_b64_tr_b16 v[86:87], v21 offset:16896
    s_add_u32 m0, s48, 131072
    s_add_u32 s42, s68, 0
    buffer_load_dwordx4 v14, s[12:15], s42 offen lds
    s_waitcnt lgkmcnt(8)
    v_mfma_f32_32x32x16_bf16 v[60:75], a[104:107], v[104:107], v[60:75]
    ds_read_b64_tr_b16 v[88:89], v21 offset:24576
    ds_read_b64_tr_b16 v[90:91], v21 offset:25088
    buffer_load_dwordx4 v15, s[12:15], s42 offen offset:1024 lds
    s_waitcnt lgkmcnt(7)
    v_mfma_f32_32x32x16_bf16 v[44:59], v[108:111], a[108:111], v[44:59]
    ds_read_b128 a[116:119], v17 offset:0
    ds_read_b64_tr_b16 v[92:93], v21 offset:18432
    ds_read_b64_tr_b16 v[94:95], v21 offset:18944
    s_waitcnt lgkmcnt(8)
    v_mfma_f32_32x32x16_bf16 v[60:75], a[108:111], v[112:115], v[60:75]
    ds_read_b64_tr_b16 v[96:97], v21 offset:26624
    ds_read_b64_tr_b16 v[98:99], v21 offset:27136
    s_waitcnt lgkmcnt(7)
    v_mfma_f32_32x32x16_bf16 v[44:59], v[84:87], a[112:115], v[44:59]
    ds_read_b128 a[120:123], v18 offset:0
    ds_read_b64_tr_b16 v[100:101], v21 offset:20480
    ds_read_b64_tr_b16 v[102:103], v21 offset:20992
    s_waitcnt lgkmcnt(8)
    v_mfma_f32_32x32x16_bf16 v[60:75], a[112:115], v[88:91], v[60:75]
    ds_read_b64_tr_b16 v[104:105], v21 offset:28672
    ds_read_b64_tr_b16 v[106:107], v21 offset:29184
    s_waitcnt lgkmcnt(7)
    v_mfma_f32_32x32x16_bf16 v[44:59], v[92:95], a[116:119], v[44:59]
    ds_read_b128 a[124:127], v19 offset:0
    ds_read_b64_tr_b16 v[108:109], v21 offset:22528
    ds_read_b64_tr_b16 v[110:111], v21 offset:23040
    s_waitcnt lgkmcnt(8)
    v_mfma_f32_32x32x16_bf16 v[60:75], a[116:119], v[96:99], v[60:75]
    ds_read_b64_tr_b16 v[112:113], v21 offset:30720
    ds_read_b64_tr_b16 v[114:115], v21 offset:31232
    s_waitcnt lgkmcnt(7)
    v_mfma_f32_32x32x16_bf16 v[44:59], v[100:103], a[120:123], v[44:59]
    s_waitcnt lgkmcnt(5)
    v_mfma_f32_32x32x16_bf16 v[60:75], a[120:123], v[104:107], v[60:75]
    s_waitcnt lgkmcnt(2)
    v_mfma_f32_32x32x16_bf16 v[44:59], v[108:111], a[124:127], v[44:59]
    s_waitcnt lgkmcnt(0)
    v_mfma_f32_32x32x16_bf16 v[60:75], a[124:127], v[112:115], v[60:75]
    s_nop 9
    v_cvt_pk_bf16_f32 v4, v44, v45
    v_cvt_pk_bf16_f32 v5, v46, v47
    v_cvt_pk_bf16_f32 v6, v48, v49
    v_cvt_pk_bf16_f32 v7, v50, v51
    v_cvt_pk_bf16_f32 v8, v52, v53
    v_cvt_pk_bf16_f32 v9, v54, v55
    v_cvt_pk_bf16_f32 v10, v56, v57
    v_cvt_pk_bf16_f32 v11, v58, v59
    v_mfma_f32_32x32x16_bf16 v[44:59], v[28:31], v[4:7], 0
    s_nop 0
    v_mfma_f32_32x32x16_bf16 v[44:59], v[32:35], v[8:11], v[44:59]
    s_nop 11
    v_max3_f32 v116, |v44|, |v45|, |v46|
    v_max3_f32 v117, |v47|, |v48|, |v49|
    v_max3_f32 v116, v116, |v50|, |v51|
    v_max3_f32 v117, v117, |v52|, |v53|
    v_max3_f32 v116, v116, |v54|, |v55|
    v_max3_f32 v117, v117, |v56|, |v57|
    v_max3_f32 v116, v116, |v58|, |v59|
    v_max_f32 v116, v116, v117
    v_cmp_lt_f32 vcc, s50, v116
    v_exp_f32 v92, -v44
    v_exp_f32 v93, -v45
    v_exp_f32 v94, -v46
    v_exp_f32 v95, -v47
    s_nop 0
    s_cbranch_vccnz L_SMK0
    v_exp_f32 v96, -v48
    v_exp_f32 v97, -v49
    v_exp_f32 v98, -v50
    v_exp_f32 v99, -v51
    v_exp_f32 v100, -v52
    v_exp_f32 v101, -v53
    v_exp_f32 v102, -v54
    v_exp_f32 v103, -v55
    v_exp_f32 v104, -v56
    v_exp_f32 v105, -v57
    v_exp_f32 v106, -v58
    v_exp_f32 v107, -v59
L_SMK0B:
    v_exp_f32 v44, v44
    v_exp_f32 v45, v45
    v_exp_f32 v46, v46
    v_add_f32 v110, v92, v94
    v_exp_f32 v47, v47
    v_add_f32 v111, v93, v95
    v_add_f32 v108, v44, v46
    v_exp_f32 v48, v48
    v_add_f32 v110, v110, v96
    v_add_f32 v109, v45, v47
    v_exp_f32 v49, v49
    v_add_f32 v111, v111, v97
    v_add_f32 v108, v108, v48
    v_exp_f32 v50, v50
    v_add_f32 v110, v110, v98
    v_add_f32 v109, v109, v49
    v_exp_f32 v51, v51
    v_add_f32 v111, v111, v99
    v_add_f32 v108, v108, v50
    v_exp_f32 v52, v52
    v_add_f32 v110, v110, v100
    v_add_f32 v109, v109, v51
    v_exp_f32 v53, v53
    v_add_f32 v111, v111, v101
    v_add_f32 v108, v108, v52
    v_exp_f32 v54, v54
    v_add_f32 v110, v110, v102
    v_add_f32 v109, v109, v53
    v_exp_f32 v55, v55
    v_add_f32 v111, v111, v103
    v_add_f32 v108, v108, v54
    v_exp_f32 v56, v56
    v_add_f32 v110, v110, v104
    v_add_f32 v109, v109, v55
    v_exp_f32 v57, v57
    v_add_f32 v111, v111, v105
    v_add_f32 v108, v108, v56
    v_exp_f32 v58, v58
    v_add_f32 v110, v110, v106
    v_add_f32 v109, v109, v57
    v_exp_f32 v59, v59
    v_add_f32 v111, v111, v107
    v_add_f32 v108, v108, v58
    v_add_f32 v109, v109, v59
    v_add_f32 v117, v110, v111
    v_add_f32 v116, v108, v109
    v_rcp_f32 v117, v117
    s_barrier
    v_cvt_pk_bf16_f32 v76, v60, v61
    v_cvt_pk_bf16_f32 v77, v62, v63
    v_cvt_pk_bf16_f32 v78, v64, v65
    v_cvt_pk_bf16_f32 v79, v66, v67
    v_cvt_pk_bf16_f32 v80, v68, v69
    v_cvt_pk_bf16_f32 v81, v70, v71
    v_cvt_pk_bf16_f32 v82, v72, v73
    v_cvt_pk_bf16_f32 v83, v74, v75
    ds_write_b128 v118, v[76:79] offset:32768
    ds_write_b128 v118, v[80:83] offset:33792
    v_rcp_f32 v116, v116
    v_mul_f32 v92, v92, v117
    v_mul_f32 v93, v93, v117
    v_mul_f32 v44, v44, v116
    v_mul_f32 v45, v45, v116
    v_mul_f32 v46, v46, v116
    v_mul_f32 v47, v47, v116
    v_cvt_pk_bf16_f32 v44, v44, v45
    v_mul_f32 v48, v48, v116
    v_mul_f32 v49, v49, v116
    v_cvt_pk_bf16_f32 v45, v46, v47
    v_mul_f32 v50, v50, v116
    v_mul_f32 v51, v51, v116
    v_cvt_pk_bf16_f32 v46, v48, v49
    v_mul_f32 v52, v52, v116
    v_mul_f32 v53, v53, v116
    v_cvt_pk_bf16_f32 v47, v50, v51
    v_mul_f32 v54, v54, v116
    v_mul_f32 v55, v55, v116
    v_cvt_pk_bf16_f32 v48, v52, v53
    v_mul_f32 v56, v56, v116
    v_mul_f32 v57, v57, v116
    v_cvt_pk_bf16_f32 v49, v54, v55
    v_mul_f32 v58, v58, v116
    v_mul_f32 v59, v59, v116
    v_cvt_pk_bf16_f32 v50, v56, v57
    v_cvt_pk_bf16_f32 v51, v58, v59
    v_mul_f32 v94, v94, v117
    v_mul_f32 v95, v95, v117
    v_cvt_pk_bf16_f32 v52, v92, v93
    v_mul_f32 v96, v96, v117
    v_mul_f32 v97, v97, v117
    v_cvt_pk_bf16_f32 v53, v94, v95
    v_mul_f32 v98, v98, v117
    v_mul_f32 v99, v99, v117
    v_cvt_pk_bf16_f32 v54, v96, v97
    v_mul_f32 v100, v100, v117
    v_mul_f32 v101, v101, v117
    v_cvt_pk_bf16_f32 v55, v98, v99
    v_mul_f32 v102, v102, v117
    v_mul_f32 v103, v103, v117
    v_cvt_pk_bf16_f32 v56, v100, v101
    v_mul_f32 v104, v104, v117
    v_mul_f32 v105, v105, v117
    v_cvt_pk_bf16_f32 v57, v102, v103
    v_mul_f32 v106, v106, v117
    v_mul_f32 v107, v107, v117
    v_cvt_pk_bf16_f32 v58, v104, v105
    v_cvt_pk_bf16_f32 v59, v106, v107
    ds_write_b128 v119, v[44:47] offset:0
    v_xor_b32 v5, 16, v119
    ds_write_b128 v5, v[48:51] offset:0
    v_xor_b32 v6, 32, v119
    ds_write_b128 v6, v[52:55] offset:0
    v_xor_b32 v7, 48, v119
    ds_write_b128 v7, v[56:59] offset:0
    s_add_u32 m0, s48, 139264
    s_add_u32 s42, s69, 0
    buffer_load_dwordx4 v14, s[12:15], s42 offen lds
    buffer_load_dwordx4 v15, s[12:15], s42 offen offset:1024 lds
    s_add_u32 m0, s48, 147456
    s_add_u32 s42, s70, 0
    buffer_load_dwordx4 v14, s[12:15], s42 offen lds
    buffer_load_dwordx4 v15, s[12:15], s42 offen offset:1024 lds
    s_add_u32 m0, s48, 155648
    s_add_u32 s42, s71, 0
    buffer_load_dwordx4 v14, s[12:15], s42 offen lds
    buffer_load_dwordx4 v15, s[12:15], s42 offen offset:1024 lds
    s_add_u32 s56, s74, 0
    s_and_b32 s56, s56, 7
    s_add_u32 s57, s74, 1
    s_and_b32 s57, s57, 7
    s_add_u32 s58, s74, 2
    s_and_b32 s58, s58, 7
    s_add_u32 s59, s74, 3
    s_and_b32 s59, s59, 7
    s_add_u32 s60, s74, 4
    s_and_b32 s60, s60, 7
    s_add_u32 s61, s74, 5
    s_and_b32 s61, s61, 7
    s_add_u32 s62, s74, 6
    s_and_b32 s62, s62, 7
    s_add_u32 s63, s74, 7
    s_and_b32 s63, s63, 7
    v_lshrrev_b32 v12, 3, v2
    v_lshl_add_u32 v12, v12, 10, v27
    s_lshl_b32 s42, s40, 14
    s_lshl_b32 s43, s73, 8
    s_add_u32 s42, s42, s43
    v_add_u32 v12, s42, v12
    v_add_u32 v13, 7168, v12
    v_add_u32 v14, 128, v12
    v_add_u32 v15, 128, v13
    s_lshl_b32 s43, s56, 16
    s_add_u32 m0, s48, 57344
    s_nop 0
    buffer_load_dwordx4 v12, s[20:23], s43 offen lds
    buffer_load_dwordx4 v13, s[20:23], s43 offen offset:1024 lds
    s_add_u32 m0, s48, 65536
    s_nop 0
    buffer_load_dwordx4 v14, s[20:23], s43 offen lds
    buffer_load_dwordx4 v15, s[20:23], s43 offen offset:1024 lds
    s_waitcnt vmcnt(14)
    s_waitcnt lgkmcnt(0)
    s_barrier
    ds_read_b64_tr_b16 v[76:77], v21 offset:32768
    ds_read_b64_tr_b16 v[78:79], v21 offset:33280
    ds_read_b64_tr_b16 v[80:81], v24 offset:32768
    ds_read_b64_tr_b16 v[82:83], v24 offset:33280
    ds_read_b64_tr_b16 v[84:85], v21 offset:34816
    ds_read_b64_tr_b16 v[86:87], v21 offset:35328
    ds_read_b64_tr_b16 v[88:89], v24 offset:34816
    ds_read_b64_tr_b16 v[90:91], v24 offset:35328
    ds_read_b64_tr_b16 v[92:93], v21 offset:36864
    ds_read_b64_tr_b16 v[94:95], v21 offset:37376
    ds_read_b64_tr_b16 v[96:97], v24 offset:36864
    ds_read_b64_tr_b16 v[98:99], v24 offset:37376
    s_waitcnt lgkmcnt(10)
    v_mfma_f32_32x32x16_bf16 v[44:59], v[76:79], a[0:3], 0
    ds_read_b64_tr_b16 v[100:101], v21 offset:38912
    ds_read_b64_tr_b16 v[102:103], v21 offset:39424
    s_waitcnt lgkmcnt(10)
    v_mfma_f32_32x32x16_bf16 v[60:75], v[80:83], a[0:3], 0
    ds_read_b64_tr_b16 v[104:105], v24 offset:38912
    ds_read_b64_tr_b16 v[106:107], v24 offset:39424
    s_waitcnt lgkmcnt(10)
    v_mfma_f32_32x32x16_bf16 v[44:59], v[84:87], a[4:7], v[44:59]
    ds_read_b64_tr_b16 v[108:109], v21 offset:40960
    ds_read_b64_tr_b16 v[110:111], v21 offset:41472
    s_waitcnt lgkmcnt(10)
    v_mfma_f32_32x32x16_bf16 v[60:75], v[88:91], a[4:7], v[60:75]
    ds_read_b64_tr_b16 v[112:113], v24 offset:40960
    ds_read_b64_tr_b16 v[114:115], v24 offset:41472
    s_waitcnt lgkmcnt(10)
    v_mfma_f32_32x32x16_bf16 v[44:59], v[92:95], a[8:11], v[44:59]
    ds_read_b64_tr_b16 v[76:77], v21 offset:43008
    ds_read_b64_tr_b16 v[78:79], v21 offset:43520
    s_waitcnt lgkmcnt(10)
    v_mfma_f32_32x32x16_bf16 v[60:75], v[96:99], a[8:11], v[60:75]
    ds_read_b64_tr_b16 v[80:81], v24 offset:43008
    ds_read_b64_tr_b16 v[82:83], v24 offset:43520
    s_waitcnt lgkmcnt(10)
    v_mfma_f32_32x32x16_bf16 v[44:59], v[100:103], a[12:15], v[44:59]
    ds_read_b64_tr_b16 v[84:85], v21 offset:45056
    ds_read_b64_tr_b16 v[86:87], v21 offset:45568
    s_waitcnt lgkmcnt(10)
    v_mfma_f32_32x32x16_bf16 v[60:75], v[104:107], a[12:15], v[60:75]
    ds_read_b64_tr_b16 v[88:89], v24 offset:45056
    ds_read_b64_tr_b16 v[90:91], v24 offset:45568
    s_waitcnt lgkmcnt(10)
    v_mfma_f32_32x32x16_bf16 v[44:59], v[108:111], a[16:19], v[44:59]
    ds_read_b64_tr_b16 v[92:93], v21 offset:47104
    ds_read_b64_tr_b16 v[94:95], v21 offset:47616
    s_waitcnt lgkmcnt(10)
    v_mfma_f32_32x32x16_bf16 v[60:75], v[112:115], a[16:19], v[60:75]
    ds_read_b64_tr_b16 v[96:97], v24 offset:47104
    ds_read_b64_tr_b16 v[98:99], v24 offset:47616
    s_waitcnt lgkmcnt(10)
    v_mfma_f32_32x32x16_bf16 v[44:59], v[76:79], a[20:23], v[44:59]
    ds_read_b64_tr_b16 v[100:101], v21 offset:49152
    ds_read_b64_tr_b16 v[102:103], v21 offset:49664
    s_waitcnt lgkmcnt(10)
    v_mfma_f32_32x32x16_bf16 v[60:75], v[80:83], a[20:23], v[60:75]
    ds_read_b64_tr_b16 v[104:105], v24 offset:49152
    ds_read_b64_tr_b16 v[106:107], v24 offset:49664
    s_waitcnt lgkmcnt(10)
    v_mfma_f32_32x32x16_bf16 v[44:59], v[84:87], a[24:27], v[44:59]
    ds_read_b64_tr_b16 v[108:109], v21 offset:51200
    ds_read_b64_tr_b16 v[110:111], v21 offset:51712
    s_waitcnt lgkmcnt(10)
    v_mfma_f32_32x32x16_bf16 v[60:75], v[88:91], a[24:27], v[60:75]
    ds_read_b64_tr_b16 v[112:113], v24 offset:51200
    ds_read_b64_tr_b16 v[114:115], v24 offset:51712
    s_waitcnt lgkmcnt(10)
    v_mfma_f32_32x32x16_bf16 v[44:59], v[92:95], a[28:31], v[44:59]
    ds_read_b64_tr_b16 v[76:77], v21 offset:53248
    ds_read_b64_tr_b16 v[78:79], v21 offset:53760
    s_waitcnt lgkmcnt(10)
    v_mfma_f32_32x32x16_bf16 v[60:75], v[96:99], a[28:31], v[60:75]
    ds_read_b64_tr_b16 v[80:81], v24 offset:53248
    ds_read_b64_tr_b16 v[82:83], v24 offset:53760
    s_waitcnt lgkmcnt(10)
    v_mfma_f32_32x32x16_bf16 v[44:59], v[100:103], a[32:35], v[44:59]
    ds_read_b64_tr_b16 v[84:85], v21 offset:55296
    ds_read_b64_tr_b16 v[86:87], v21 offset:55808
    s_waitcnt lgkmcnt(10)
    v_mfma_f32_32x32x16_bf16 v[60:75], v[104:107], a[32:35], v[60:75]
    ds_read_b64_tr_b16 v[88:89], v24 offset:55296
    ds_read_b64_tr_b16 v[90:91], v24 offset:55808
    s_waitcnt vmcnt(4)
    s_barrier
    s_waitcnt lgkmcnt(10)
    v_mfma_f32_32x32x16_bf16 v[44:59], v[108:111], a[36:39], v[44:59]
    ds_read_b64_tr_b16 v[92:93], v21 offset:57344
    ds_read_b64_tr_b16 v[94:95], v21 offset:57856
    s_waitcnt lgkmcnt(10)
    v_mfma_f32_32x32x16_bf16 v[60:75], v[112:115], a[36:39], v[60:75]
    ds_read_b64_tr_b16 v[96:97], v24 offset:57344
    ds_read_b64_tr_b16 v[98:99], v24 offset:57856
    s_waitcnt lgkmcnt(10)
    v_mfma_f32_32x32x16_bf16 v[44:59], v[76:79], a[40:43], v[44:59]
    ds_read_b64_tr_b16 v[100:101], v21 offset:59392
    ds_read_b64_tr_b16 v[102:103], v21 offset:59904
    s_waitcnt lgkmcnt(10)
    v_mfma_f32_32x32x16_bf16 v[60:75], v[80:83], a[40:43], v[60:75]
    ds_read_b64_tr_b16 v[104:105], v24 offset:59392
    ds_read_b64_tr_b16 v[106:107], v24 offset:59904
    s_waitcnt lgkmcnt(10)
    v_mfma_f32_32x32x16_bf16 v[44:59], v[84:87], a[44:47], v[44:59]
    ds_read_b64_tr_b16 v[108:109], v21 offset:61440
    ds_read_b64_tr_b16 v[110:111], v21 offset:61952
    s_waitcnt lgkmcnt(10)
    v_mfma_f32_32x32x16_bf16 v[60:75], v[88:91], a[44:47], v[60:75]
    ds_read_b64_tr_b16 v[112:113], v24 offset:61440
    ds_read_b64_tr_b16 v[114:115], v24 offset:61952
    s_waitcnt lgkmcnt(10)
    v_mfma_f32_32x32x16_bf16 v[44:59], v[92:95], a[48:51], v[44:59]
    ds_read_b64_tr_b16 v[76:77], v21 offset:63488
    ds_read_b64_tr_b16 v[78:79], v21 offset:64000
    v_bfe_u32 v119, v2, 3, 2
    v_and_b32 v120, 3, v2
    s_waitcnt lgkmcnt(10)
    v_mfma_f32_32x32x16_bf16 v[60:75], v[96:99], a[48:51], v[60:75]
    ds_read_b64_tr_b16 v[80:81], v24 offset:63488
    ds_read_b64_tr_b16 v[82:83], v24 offset:64000
    v_lshl_add_u32 v119, v119, 2, v120
    v_lshl_add_u32 v119, v3, 4, v119
    s_waitcnt lgkmcnt(10)
    v_mfma_f32_32x32x16_bf16 v[44:59], v[100:103], a[52:55], v[44:59]
    ds_read_b64_tr_b16 v[84:85], v22 offset:0
    ds_read_b64_tr_b16 v[86:87], v22 offset:512
    v_mul_u32_u24 v119, 80, v119
    v_lshlrev_b32 v120, 6, v3
    s_waitcnt lgkmcnt(10)
    v_mfma_f32_32x32x16_bf16 v[60:75], v[104:107], a[52:55], v[60:75]
    ds_read_b64_tr_b16 v[88:89], v25 offset:0
    ds_read_b64_tr_b16 v[90:91], v25 offset:512
    v_accvgpr_write_b32 a0, 0
    v_accvgpr_write_b32 a1, 0
    s_waitcnt lgkmcnt(10)
    v_mfma_f32_32x32x16_bf16 v[44:59], v[108:111], a[56:59], v[44:59]
    ds_read_b64_tr_b16 v[92:93], v22 offset:2048
    ds_read_b64_tr_b16 v[94:95], v22 offset:2560
    v_accvgpr_write_b32 a2, 0
    v_accvgpr_write_b32 a3, 0
    s_waitcnt lgkmcnt(10)
    v_mfma_f32_32x32x16_bf16 v[60:75], v[112:115], a[56:59], v[60:75]
    ds_read_b64_tr_b16 v[96:97], v25 offset:2048
    ds_read_b64_tr_b16 v[98:99], v25 offset:2560
    v_accvgpr_write_b32 a4, 0
    v_accvgpr_write_b32 a5, 0
    s_waitcnt lgkmcnt(10)
    v_mfma_f32_32x32x16_bf16 v[44:59], v[76:79], a[60:63], v[44:59]
    ds_read_b64_tr_b16 v[100:101], v22 offset:4096
    ds_read_b64_tr_b16 v[102:103], v22 offset:4608
    v_accvgpr_write_b32 a6, 0
    v_accvgpr_write_b32 a7, 0
    s_waitcnt lgkmcnt(10)
    v_mfma_f32_32x32x16_bf16 v[60:75], v[80:83], a[60:63], v[60:75]
    ds_read_b64_tr_b16 v[104:105], v25 offset:4096
    ds_read_b64_tr_b16 v[106:107], v25 offset:4608
    v_accvgpr_write_b32 a8, 0
    v_accvgpr_write_b32 a9, 0
    s_waitcnt lgkmcnt(10)
    v_mfma_f32_32x32x16_bf16 v[44:59], v[84:87], a[64:67], v[44:59]
    ds_read_b64_tr_b16 v[108:109], v22 offset:6144
    ds_read_b64_tr_b16 v[110:111], v22 offset:6656
    v_accvgpr_write_b32 a10, 0
    v_accvgpr_write_b32 a11, 0
    s_waitcnt lgkmcnt(10)
    v_mfma_f32_32x32x16_bf16 v[60:75], v[88:91], a[64:67], v[60:75]
    ds_read_b64_tr_b16 v[112:113], v25 offset:6144
    ds_read_b64_tr_b16 v[114:115], v25 offset:6656
    v_accvgpr_write_b32 a12, 0
    v_accvgpr_write_b32 a13, 0
    s_waitcnt lgkmcnt(10)
    v_mfma_f32_32x32x16_bf16 v[44:59], v[92:95], a[68:71], v[44:59]
    ds_read_b64_tr_b16 v[76:77], v22 offset:8192
    ds_read_b64_tr_b16 v[78:79], v22 offset:8704
    v_accvgpr_write_b32 a14, 0
    v_accvgpr_write_b32 a15, 0
    s_waitcnt lgkmcnt(10)
    v_mfma_f32_32x32x16_bf16 v[60:75], v[96:99], a[68:71], v[60:75]
    ds_read_b64_tr_b16 v[80:81], v25 offset:8192
    ds_read_b64_tr_b16 v[82:83], v25 offset:8704
    v_accvgpr_write_b32 a16, 0
    v_accvgpr_write_b32 a17, 0
    s_waitcnt lgkmcnt(10)
    v_mfma_f32_32x32x16_bf16 v[44:59], v[100:103], a[72:75], v[44:59]
    ds_read_b64_tr_b16 v[84:85], v22 offset:10240
    ds_read_b64_tr_b16 v[86:87], v22 offset:10752
    v_accvgpr_write_b32 a18, 0
    v_accvgpr_write_b32 a19, 0
    s_waitcnt lgkmcnt(10)
    v_mfma_f32_32x32x16_bf16 v[60:75], v[104:107], a[72:75], v[60:75]
    ds_read_b64_tr_b16 v[88:89], v25 offset:10240
    ds_read_b64_tr_b16 v[90:91], v25 offset:10752
    v_accvgpr_write_b32 a20, 0
    v_accvgpr_write_b32 a21, 0
    s_waitcnt lgkmcnt(10)
    v_mfma_f32_32x32x16_bf16 v[44:59], v[108:111], a[76:79], v[44:59]
    ds_read_b64_tr_b16 v[92:93], v22 offset:12288
    ds_read_b64_tr_b16 v[94:95], v22 offset:12800
    v_accvgpr_write_b32 a22, 0
    v_accvgpr_write_b32 a23, 0
    s_waitcnt lgkmcnt(10)
    v_mfma_f32_32x32x16_bf16 v[60:75], v[112:115], a[76:79], v[60:75]
    ds_read_b64_tr_b16 v[96:97], v25 offset:12288
    ds_read_b64_tr_b16 v[98:99], v25 offset:12800
    v_accvgpr_write_b32 a24, 0
    v_accvgpr_write_b32 a25, 0
    s_waitcnt lgkmcnt(10)
    v_mfma_f32_32x32x16_bf16 v[44:59], v[76:79], a[80:83], v[44:59]
    ds_read_b64_tr_b16 v[100:101], v22 offset:14336
    ds_read_b64_tr_b16 v[102:103], v22 offset:14848
    v_accvgpr_write_b32 a26, 0
    v_accvgpr_write_b32 a27, 0
    s_waitcnt lgkmcnt(10)
    v_mfma_f32_32x32x16_bf16 v[60:75], v[80:83], a[80:83], v[60:75]
    ds_read_b64_tr_b16 v[104:105], v25 offset:14336
    ds_read_b64_tr_b16 v[106:107], v25 offset:14848
    v_accvgpr_write_b32 a28, 0
    v_accvgpr_write_b32 a29, 0
    s_waitcnt lgkmcnt(10)
    v_mfma_f32_32x32x16_bf16 v[44:59], v[84:87], a[84:87], v[44:59]
    ds_read_b64_tr_b16 v[108:109], v22 offset:16384
    ds_read_b64_tr_b16 v[110:111], v22 offset:16896
    v_accvgpr_write_b32 a30, 0
    v_accvgpr_write_b32 a31, 0
    s_waitcnt lgkmcnt(10)
    v_mfma_f32_32x32x16_bf16 v[60:75], v[88:91], a[84:87], v[60:75]
    ds_read_b64_tr_b16 v[112:113], v25 offset:16384
    ds_read_b64_tr_b16 v[114:115], v25 offset:16896
    v_mov_b32 v4, 0x358637bd
    v_mov_b32 v8, 0x358637bd
    s_waitcnt lgkmcnt(10)
    v_mfma_f32_32x32x16_bf16 v[44:59], v[92:95], a[88:91], v[44:59]
    ds_read_b64_tr_b16 v[76:77], v22 offset:18432
    ds_read_b64_tr_b16 v[78:79], v22 offset:18944
    s_waitcnt lgkmcnt(10)
    v_mfma_f32_32x32x16_bf16 v[60:75], v[96:99], a[88:91], v[60:75]
    ds_read_b64_tr_b16 v[80:81], v25 offset:18432
    ds_read_b64_tr_b16 v[82:83], v25 offset:18944
    s_waitcnt lgkmcnt(10)
    v_mfma_f32_32x32x16_bf16 v[44:59], v[100:103], a[92:95], v[44:59]
    ds_read_b64_tr_b16 v[84:85], v22 offset:20480
    ds_read_b64_tr_b16 v[86:87], v22 offset:20992
    s_waitcnt lgkmcnt(10)
    v_mfma_f32_32x32x16_bf16 v[60:75], v[104:107], a[92:95], v[60:75]
    ds_read_b64_tr_b16 v[88:89], v25 offset:20480
    ds_read_b64_tr_b16 v[90:91], v25 offset:20992
    s_waitcnt lgkmcnt(10)
    v_mfma_f32_32x32x16_bf16 v[44:59], v[108:111], a[96:99], v[44:59]
    ds_read_b64_tr_b16 v[92:93], v22 offset:22528
    ds_read_b64_tr_b16 v[94:95], v22 offset:23040
    s_waitcnt lgkmcnt(10)
    v_mfma_f32_32x32x16_bf16 v[60:75], v[112:115], a[96:99], v[60:75]
    ds_read_b64_tr_b16 v[96:97], v25 offset:22528
    ds_read_b64_tr_b16 v[98:99], v25 offset:23040
    s_waitcnt lgkmcnt(10)
    v_mfma_f32_32x32x16_bf16 v[44:59], v[76:79], a[100:103], v[44:59]
    ds_read_b64_tr_b16 v[100:101], v22 offset:24576
    ds_read_b64_tr_b16 v[102:103], v22 offset:25088
    s_waitcnt lgkmcnt(10)
    v_mfma_f32_32x32x16_bf16 v[60:75], v[80:83], a[100:103], v[60:75]
    ds_read_b64_tr_b16 v[104:105], v25 offset:24576
    ds_read_b64_tr_b16 v[106:107], v25 offset:25088
    s_waitcnt lgkmcnt(10)
    v_mfma_f32_32x32x16_bf16 v[44:59], v[84:87], a[104:107], v[44:59]
    ds_read_b64_tr_b16 v[108:109], v22 offset:26624
    ds_read_b64_tr_b16 v[110:111], v22 offset:27136
    s_waitcnt lgkmcnt(10)
    v_mfma_f32_32x32x16_bf16 v[60:75], v[88:91], a[104:107], v[60:75]
    ds_read_b64_tr_b16 v[112:113], v25 offset:26624
    ds_read_b64_tr_b16 v[114:115], v25 offset:27136
    s_waitcnt lgkmcnt(10)
    v_mfma_f32_32x32x16_bf16 v[44:59], v[92:95], a[108:111], v[44:59]
    ds_read_b64_tr_b16 v[76:77], v22 offset:28672
    ds_read_b64_tr_b16 v[78:79], v22 offset:29184
    s_waitcnt lgkmcnt(10)
    v_mfma_f32_32x32x16_bf16 v[60:75], v[96:99], a[108:111], v[60:75]
    ds_read_b64_tr_b16 v[80:81], v25 offset:28672
    ds_read_b64_tr_b16 v[82:83], v25 offset:29184
    s_waitcnt lgkmcnt(10)
    v_mfma_f32_32x32x16_bf16 v[44:59], v[100:103], a[112:115], v[44:59]
    ds_read_b64_tr_b16 v[84:85], v22 offset:30720
    ds_read_b64_tr_b16 v[86:87], v22 offset:31232
    s_waitcnt lgkmcnt(10)
    v_mfma_f32_32x32x16_bf16 v[60:75], v[104:107], a[112:115], v[60:75]
    ds_read_b64_tr_b16 v[88:89], v25 offset:30720
    ds_read_b64_tr_b16 v[90:91], v25 offset:31232
    s_waitcnt lgkmcnt(10)
    v_mfma_f32_32x32x16_bf16 v[44:59], v[108:111], a[116:119], v[44:59]
    s_waitcnt lgkmcnt(8)
    v_mfma_f32_32x32x16_bf16 v[60:75], v[112:115], a[116:119], v[60:75]
    s_waitcnt lgkmcnt(6)
    v_mfma_f32_32x32x16_bf16 v[44:59], v[76:79], a[120:123], v[44:59]
    s_waitcnt lgkmcnt(4)
    v_mfma_f32_32x32x16_bf16 v[60:75], v[80:83], a[120:123], v[60:75]
    s_waitcnt lgkmcnt(2)
    v_mfma_f32_32x32x16_bf16 v[44:59], v[84:87], a[124:127], v[44:59]
    s_waitcnt lgkmcnt(0)
    v_mfma_f32_32x32x16_bf16 v[60:75], v[88:91], a[124:127], v[60:75]
    s_nop 9
    v_cvt_pk_bf16_f32 v76, v44, v45
    v_cvt_pk_bf16_f32 v77, v46, v47
    v_cvt_pk_bf16_f32 v78, v48, v49
    v_cvt_pk_bf16_f32 v79, v50, v51
    v_cvt_pk_bf16_f32 v80, v52, v53
    v_cvt_pk_bf16_f32 v81, v54, v55
    v_cvt_pk_bf16_f32 v82, v56, v57
    v_cvt_pk_bf16_f32 v83, v58, v59
    v_mfma_f32_32x32x16_bf16 v[44:59], v[28:31], v[76:79], 0
    s_nop 0
    v_mfma_f32_32x32x16_bf16 v[44:59], v[32:35], v[80:83], v[44:59]
    v_cvt_pk_bf16_f32 v84, v60, v61
    v_cvt_pk_bf16_f32 v85, v62, v63
    v_cvt_pk_bf16_f32 v86, v64, v65
    v_cvt_pk_bf16_f32 v87, v66, v67
    v_cvt_pk_bf16_f32 v88, v68, v69
    v_cvt_pk_bf16_f32 v89, v70, v71
    v_cvt_pk_bf16_f32 v90, v72, v73
    v_cvt_pk_bf16_f32 v91, v74, v75
    v_mfma_f32_32x32x16_bf16 v[60:75], v[36:39], v[84:87], 0
    s_nop 0
    v_mfma_f32_32x32x16_bf16 v[60:75], v[40:43], v[88:91], v[60:75]
    s_nop 0
    v_max3_f32 v116, |v44|, |v45|, |v46|
    v_max3_f32 v117, |v47|, |v48|, |v49|
    v_max3_f32 v116, v116, |v50|, |v51|
    v_max3_f32 v117, v117, |v52|, |v53|
    v_max3_f32 v116, v116, |v54|, |v55|
    v_max3_f32 v117, v117, |v56|, |v57|
    v_max3_f32 v116, v116, |v58|, |v59|
    v_max_f32 v116, v116, v117
    v_cmp_lt_f32 vcc, s50, v116
    v_exp_f32 v92, -v44
    v_exp_f32 v93, -v45
    v_exp_f32 v94, -v46
    v_exp_f32 v95, -v47
    s_nop 0
    s_cbranch_vccnz L_SMQ0
    v_exp_f32 v96, -v48
    v_exp_f32 v97, -v49
    v_exp_f32 v98, -v50
    v_exp_f32 v99, -v51
    v_exp_f32 v100, -v52
    v_exp_f32 v101, -v53
    v_exp_f32 v102, -v54
    v_exp_f32 v103, -v55
    v_exp_f32 v104, -v56
    v_exp_f32 v105, -v57
    v_exp_f32 v106, -v58
    v_exp_f32 v107, -v59
L_SMQ0B:
    v_exp_f32 v44, v44
    v_exp_f32 v45, v45
    v_exp_f32 v46, v46
    v_exp_f32 v47, v47
    v_pk_add_f32 v[110:111], v[92:93], v[94:95]
    v_exp_f32 v48, v48
    v_exp_f32 v49, v49
    v_pk_add_f32 v[110:111], v[110:111], v[96:97]
    v_pk_add_f32 v[108:109], v[44:45], v[46:47]
    v_exp_f32 v50, v50
    v_exp_f32 v51, v51
    v_pk_add_f32 v[110:111], v[110:111], v[98:99]
    v_pk_add_f32 v[108:109], v[108:109], v[48:49]
    v_exp_f32 v52, v52
    v_exp_f32 v53, v53
    v_pk_add_f32 v[110:111], v[110:111], v[100:101]
    v_pk_add_f32 v[108:109], v[108:109], v[50:51]
    v_exp_f32 v54, v54
    v_exp_f32 v55, v55
    v_pk_add_f32 v[110:111], v[110:111], v[102:103]
    v_pk_add_f32 v[108:109], v[108:109], v[52:53]
    v_exp_f32 v56, v56
    v_exp_f32 v57, v57
    v_pk_add_f32 v[110:111], v[110:111], v[104:105]
    v_pk_add_f32 v[108:109], v[108:109], v[54:55]
    v_exp_f32 v58, v58
    v_exp_f32 v59, v59
    v_pk_add_f32 v[110:111], v[110:111], v[106:107]
    v_pk_add_f32 v[108:109], v[108:109], v[56:57]
    v_pk_add_f32 v[108:109], v[108:109], v[58:59]
    v_add_f32 v117, v110, v111
    v_add_f32 v116, v108, v109
    v_rcp_f32 v114, v117
    v_rcp_f32 v112, v116
    v_mov_b32 v115, v114
    v_mov_b32 v113, v112
    v_pk_mul_f32 v[92:93], v[92:93], v[114:115]
    v_pk_mul_f32 v[44:45], v[44:45], v[112:113]
    v_pk_mul_f32 v[46:47], v[46:47], v[112:113]
    v_cvt_pk_bf16_f32 v44, v44, v45
    v_pk_mul_f32 v[48:49], v[48:49], v[112:113]
    v_cvt_pk_bf16_f32 v45, v46, v47
    v_pk_mul_f32 v[50:51], v[50:51], v[112:113]
    v_cvt_pk_bf16_f32 v46, v48, v49
    v_pk_mul_f32 v[52:53], v[52:53], v[112:113]
    v_cvt_pk_bf16_f32 v47, v50, v51
    v_pk_mul_f32 v[54:55], v[54:55], v[112:113]
    v_cvt_pk_bf16_f32 v48, v52, v53
    v_pk_mul_f32 v[56:57], v[56:57], v[112:113]
    v_cvt_pk_bf16_f32 v49, v54, v55
    v_pk_mul_f32 v[58:59], v[58:59], v[112:113]
    v_cvt_pk_bf16_f32 v50, v56, v57
    v_cvt_pk_bf16_f32 v51, v58, v59
    v_pk_mul_f32 v[94:95], v[94:95], v[114:115]
    v_cvt_pk_bf16_f32 v52, v92, v93
    v_pk_mul_f32 v[96:97], v[96:97], v[114:115]
    v_cvt_pk_bf16_f32 v53, v94, v95
    v_pk_mul_f32 v[98:99], v[98:99], v[114:115]
    v_cvt_pk_bf16_f32 v54, v96, v97
    v_pk_mul_f32 v[100:101], v[100:101], v[114:115]
    v_cvt_pk_bf16_f32 v55, v98, v99
    v_pk_mul_f32 v[102:103], v[102:103], v[114:115]
    v_cvt_pk_bf16_f32 v56, v100, v101
    v_pk_mul_f32 v[104:105], v[104:105], v[114:115]
    v_cvt_pk_bf16_f32 v57, v102, v103
    v_pk_mul_f32 v[106:107], v[106:107], v[114:115]
    v_cvt_pk_bf16_f32 v58, v104, v105
    v_cvt_pk_bf16_f32 v59, v106, v107
    s_waitcnt vmcnt(0)
    s_barrier
    s_mov_b32 exec_lo, 0x0f0f0f0f
    s_mov_b32 exec_hi, 0xf0f0f0f0
    ds_read_b128 a[0:3], v119 offset:49152
    ds_read_b128 a[4:7], v119 offset:49168
    ds_read_b128 a[8:11], v119 offset:49184
    ds_read_b128 a[12:15], v119 offset:49200
    s_mov_b64 exec, -1
    ds_read_b128 v[28:31], v120 offset:54272
    ds_read_b128 v[32:35], v120 offset:54288
    ds_read_b128 v[36:39], v120 offset:54304
    ds_read_b128 v[40:43], v120 offset:54320
    s_mov_b32 exec_lo, 0x0f0f0f0f
    s_mov_b32 exec_hi, 0xf0f0f0f0
    ds_read_b128 a[16:19], v119 offset:51712
    ds_read_b128 a[20:23], v119 offset:51728
    ds_read_b128 a[24:27], v119 offset:51744
    ds_read_b128 a[28:31], v119 offset:51760
    s_mov_b64 exec, -1
    s_waitcnt lgkmcnt(11)
    v_mfma_f32_32x32x16_bf16 v[76:91], a[0:3], v[44:47], 0
    s_waitcnt lgkmcnt(10)
    v_mfma_f32_32x32x16_bf16 v[76:91], a[4:7], v[48:51], v[76:91]
    s_waitcnt lgkmcnt(9)
    v_mfma_f32_32x32x16_bf16 v[76:91], a[8:11], v[52:55], v[76:91]
    s_waitcnt lgkmcnt(8)
    v_mfma_f32_32x32x16_bf16 v[76:91], a[12:15], v[56:59], v[76:91]
    s_waitcnt lgkmcnt(7)
    v_dot2_f32_bf16 v4, v44, v28, v4
    v_dot2_f32_bf16 v5, v45, v29, 0
    v_dot2_f32_bf16 v6, v46, v30, 0
    v_dot2_f32_bf16 v7, v47, v31, 0
    s_waitcnt lgkmcnt(6)
    v_dot2_f32_bf16 v4, v48, v32, v4
    v_dot2_f32_bf16 v5, v49, v33, v5
    v_dot2_f32_bf16 v6, v50, v34, v6
    v_dot2_f32_bf16 v7, v51, v35, v7
    s_waitcnt lgkmcnt(5)
    v_dot2_f32_bf16 v4, v52, v36, v4
    v_dot2_f32_bf16 v5, v53, v37, v5
    v_dot2_f32_bf16 v6, v54, v38, v6
    v_dot2_f32_bf16 v7, v55, v39, v7
    s_waitcnt lgkmcnt(4)
    v_dot2_f32_bf16 v4, v56, v40, v4
    v_dot2_f32_bf16 v5, v57, v41, v5
    v_dot2_f32_bf16 v6, v58, v42, v6
    v_dot2_f32_bf16 v7, v59, v43, v7
    s_nop 0
    v_add_f32 v4, v4, v5
    s_nop 0
    v_add_f32 v6, v6, v7
    v_add_f32 v4, v4, v6
    v_rcp_f32 v4, v4
    s_nop 0
    v_mul_f32 v76, v76, v4
    v_mul_f32 v77, v77, v4
    v_mul_f32 v78, v78, v4
    v_mul_f32 v79, v79, v4
    v_mul_f32 v80, v80, v4
    v_mul_f32 v81, v81, v4
    v_mul_f32 v82, v82, v4
    v_mul_f32 v83, v83, v4
    v_cvt_pk_bf16_f32 v44, v76, v77
    v_cvt_pk_bf16_f32 v45, v78, v79
    v_cvt_pk_bf16_f32 v46, v80, v81
    v_cvt_pk_bf16_f32 v47, v82, v83
    v_min_u32 v44, -3, v44
    v_min_u32 v45, -3, v45
    v_min_u32 v46, -3, v46
    v_min_u32 v47, -3, v47
    buffer_store_dwordx4 v[44:47], v26, s[28:31], s49 offen offset:0 sc1
    v_mul_f32 v84, v84, v4
    v_mul_f32 v85, v85, v4
    v_mul_f32 v86, v86, v4
    v_mul_f32 v87, v87, v4
    v_mul_f32 v88, v88, v4
    v_mul_f32 v89, v89, v4
    v_mul_f32 v90, v90, v4
    v_mul_f32 v91, v91, v4
    v_cvt_pk_bf16_f32 v48, v84, v85
    v_cvt_pk_bf16_f32 v49, v86, v87
    v_cvt_pk_bf16_f32 v50, v88, v89
    v_cvt_pk_bf16_f32 v51, v90, v91
    v_min_u32 v48, -3, v48
    v_min_u32 v49, -3, v49
    v_min_u32 v50, -3, v50
    v_min_u32 v51, -3, v51
    buffer_store_dwordx4 v[48:51], v26, s[28:31], s49 offen offset:1024 sc1
    ds_read_b128 v[28:31], v120 offset:54400
    ds_read_b128 v[32:35], v120 offset:54416
    ds_read_b128 v[36:39], v120 offset:54432
    ds_read_b128 v[40:43], v120 offset:54448
    v_max3_f32 v116, |v60|, |v61|, |v62|
    v_max3_f32 v117, |v63|, |v64|, |v65|
    v_max3_f32 v116, v116, |v66|, |v67|
    v_max3_f32 v117, v117, |v68|, |v69|
    v_max3_f32 v116, v116, |v70|, |v71|
    v_max3_f32 v117, v117, |v72|, |v73|
    v_max3_f32 v116, v116, |v74|, |v75|
    v_max_f32 v116, v116, v117
    v_cmp_lt_f32 vcc, s50, v116
    v_exp_f32 v92, -v60
    v_exp_f32 v93, -v61
    v_exp_f32 v94, -v62
    v_exp_f32 v95, -v63
    s_nop 0
    s_cbranch_vccnz L_SMQ1
    v_exp_f32 v96, -v64
    v_exp_f32 v97, -v65
    v_exp_f32 v98, -v66
    v_exp_f32 v99, -v67
    v_exp_f32 v100, -v68
    v_exp_f32 v101, -v69
    v_exp_f32 v102, -v70
    v_exp_f32 v103, -v71
    v_exp_f32 v104, -v72
    v_exp_f32 v105, -v73
    v_exp_f32 v106, -v74
    v_exp_f32 v107, -v75
L_SMQ1B:
    v_exp_f32 v60, v60
    v_exp_f32 v61, v61
    v_exp_f32 v62, v62
    v_exp_f32 v63, v63
    v_pk_add_f32 v[110:111], v[92:93], v[94:95]
    v_exp_f32 v64, v64
    v_exp_f32 v65, v65
    v_pk_add_f32 v[110:111], v[110:111], v[96:97]
    v_pk_add_f32 v[108:109], v[60:61], v[62:63]
    v_exp_f32 v66, v66
    v_exp_f32 v67, v67
    v_pk_add_f32 v[110:111], v[110:111], v[98:99]
    v_pk_add_f32 v[108:109], v[108:109], v[64:65]
    v_exp_f32 v68, v68
    v_exp_f32 v69, v69
    v_pk_add_f32 v[110:111], v[110:111], v[100:101]
    v_pk_add_f32 v[108:109], v[108:109], v[66:67]
    v_exp_f32 v70, v70
    v_exp_f32 v71, v71
    v_pk_add_f32 v[110:111], v[110:111], v[102:103]
    v_pk_add_f32 v[108:109], v[108:109], v[68:69]
    v_exp_f32 v72, v72
    v_exp_f32 v73, v73
    v_pk_add_f32 v[110:111], v[110:111], v[104:105]
    v_pk_add_f32 v[108:109], v[108:109], v[70:71]
    v_exp_f32 v74, v74
    v_exp_f32 v75, v75
    v_pk_add_f32 v[110:111], v[110:111], v[106:107]
    v_pk_add_f32 v[108:109], v[108:109], v[72:73]
    v_pk_add_f32 v[108:109], v[108:109], v[74:75]
    v_add_f32 v117, v110, v111
    v_add_f32 v116, v108, v109
    v_rcp_f32 v114, v117
    v_rcp_f32 v112, v116
    v_mov_b32 v115, v114
    v_mov_b32 v113, v112
    v_pk_mul_f32 v[92:93], v[92:93], v[114:115]
    v_pk_mul_f32 v[60:61], v[60:61], v[112:113]
    v_pk_mul_f32 v[62:63], v[62:63], v[112:113]
    v_cvt_pk_bf16_f32 v60, v60, v61
    v_pk_mul_f32 v[64:65], v[64:65], v[112:113]
    v_cvt_pk_bf16_f32 v61, v62, v63
    v_pk_mul_f32 v[66:67], v[66:67], v[112:113]
    v_cvt_pk_bf16_f32 v62, v64, v65
    v_pk_mul_f32 v[68:69], v[68:69], v[112:113]
    v_cvt_pk_bf16_f32 v63, v66, v67
    v_pk_mul_f32 v[70:71], v[70:71], v[112:113]
    v_cvt_pk_bf16_f32 v64, v68, v69
    v_pk_mul_f32 v[72:73], v[72:73], v[112:113]
    v_cvt_pk_bf16_f32 v65, v70, v71
    v_pk_mul_f32 v[74:75], v[74:75], v[112:113]
    v_cvt_pk_bf16_f32 v66, v72, v73
    v_cvt_pk_bf16_f32 v67, v74, v75
    v_pk_mul_f32 v[94:95], v[94:95], v[114:115]
    v_cvt_pk_bf16_f32 v68, v92, v93
    v_pk_mul_f32 v[96:97], v[96:97], v[114:115]
    v_cvt_pk_bf16_f32 v69, v94, v95
    v_pk_mul_f32 v[98:99], v[98:99], v[114:115]
    v_cvt_pk_bf16_f32 v70, v96, v97
    v_pk_mul_f32 v[100:101], v[100:101], v[114:115]
    v_cvt_pk_bf16_f32 v71, v98, v99
    s_barrier
    v_pk_mul_f32 v[102:103], v[102:103], v[114:115]
    v_cvt_pk_bf16_f32 v72, v100, v101
    v_pk_mul_f32 v[104:105], v[104:105], v[114:115]
    v_cvt_pk_bf16_f32 v73, v102, v103
    v_pk_mul_f32 v[106:107], v[106:107], v[114:115]
    v_cvt_pk_bf16_f32 v74, v104, v105
    v_cvt_pk_bf16_f32 v75, v106, v107
    s_waitcnt lgkmcnt(7)
    v_mfma_f32_32x32x16_bf16 v[76:91], a[16:19], v[60:63], 0
    s_waitcnt lgkmcnt(6)
    v_mfma_f32_32x32x16_bf16 v[76:91], a[20:23], v[64:67], v[76:91]
    s_waitcnt lgkmcnt(5)
    v_mfma_f32_32x32x16_bf16 v[76:91], a[24:27], v[68:71], v[76:91]
    s_waitcnt lgkmcnt(4)
    v_mfma_f32_32x32x16_bf16 v[76:91], a[28:31], v[72:75], v[76:91]
    s_waitcnt lgkmcnt(3)
    v_dot2_f32_bf16 v8, v60, v28, v8
    v_dot2_f32_bf16 v9, v61, v29, 0
    v_dot2_f32_bf16 v10, v62, v30, 0
    v_dot2_f32_bf16 v11, v63, v31, 0
    s_waitcnt lgkmcnt(2)
    v_dot2_f32_bf16 v8, v64, v32, v8
    v_dot2_f32_bf16 v9, v65, v33, v9
    v_dot2_f32_bf16 v10, v66, v34, v10
    v_dot2_f32_bf16 v11, v67, v35, v11
    s_waitcnt lgkmcnt(1)
    v_dot2_f32_bf16 v8, v68, v36, v8
    v_dot2_f32_bf16 v9, v69, v37, v9
    v_dot2_f32_bf16 v10, v70, v38, v10
    v_dot2_f32_bf16 v11, v71, v39, v11
    s_waitcnt lgkmcnt(0)
    v_dot2_f32_bf16 v8, v72, v40, v8
    v_dot2_f32_bf16 v9, v73, v41, v9
    v_dot2_f32_bf16 v10, v74, v42, v10
    v_dot2_f32_bf16 v11, v75, v43, v11
    s_nop 0
    v_add_f32 v8, v8, v9
    s_nop 0
    v_add_f32 v10, v10, v11
    v_add_f32 v8, v8, v10
    v_rcp_f32 v8, v8
    s_nop 0
    v_mul_f32 v76, v76, v8
    v_mul_f32 v77, v77, v8
    v_mul_f32 v78, v78, v8
    v_mul_f32 v79, v79, v8
    v_mul_f32 v80, v80, v8
    v_mul_f32 v81, v81, v8
    v_mul_f32 v82, v82, v8
    v_mul_f32 v83, v83, v8
    v_cvt_pk_bf16_f32 v60, v76, v77
    v_cvt_pk_bf16_f32 v61, v78, v79
    v_cvt_pk_bf16_f32 v62, v80, v81
    v_cvt_pk_bf16_f32 v63, v82, v83
    v_min_u32 v60, -3, v60
    v_min_u32 v61, -3, v61
    v_min_u32 v62, -3, v62
    v_min_u32 v63, -3, v63
    buffer_store_dwordx4 v[60:63], v26, s[28:31], s49 offen offset:2048 sc1
    v_mul_f32 v84, v84, v8
    v_mul_f32 v85, v85, v8
    v_mul_f32 v86, v86, v8
    v_mul_f32 v87, v87, v8
    v_mul_f32 v88, v88, v8
    v_mul_f32 v89, v89, v8
    v_mul_f32 v90, v90, v8
    v_mul_f32 v91, v91, v8
    v_cvt_pk_bf16_f32 v64, v84, v85
    v_cvt_pk_bf16_f32 v65, v86, v87
    v_cvt_pk_bf16_f32 v66, v88, v89
    v_cvt_pk_bf16_f32 v67, v90, v91
    v_min_u32 v64, -3, v64
    v_min_u32 v65, -3, v65
    v_min_u32 v66, -3, v66
    v_min_u32 v67, -3, v67
    buffer_store_dwordx4 v[64:67], v26, s[28:31], s49 offen offset:3072 sc1
    s_lshr_b32 s44, s40, 1
    s_add_u32 s44, s44, s74
    s_and_b32 s43, s40, 1
    s_lshl_b32 s43, s43, 10
    s_add_u32 s43, s43, s75
    s_add_u32 s64, s44, 0
    s_and_b32 s64, s64, 7
    s_lshl_b32 s64, s64, 12
    s_add_u32 s64, s64, s43
    s_add_u32 s65, s44, 2
    s_and_b32 s65, s65, 7
    s_lshl_b32 s65, s65, 12
    s_add_u32 s65, s65, s43
    s_add_u32 s66, s44, 4
    s_and_b32 s66, s66, 7
    s_lshl_b32 s66, s66, 12
    s_add_u32 s66, s66, s43
    s_add_u32 s67, s44, 6
    s_and_b32 s67, s67, 7
    s_lshl_b32 s67, s67, 12
    s_add_u32 s67, s67, s43
    v_add_u32 v13, 0x8000, v26
    v_add_u32 v16, 0x800, v26
    v_add_u32 v17, 0x8800, v26
    s_lshl_b32 s44, s40, 10
    s_add_u32 s48, s44, 98304
    v_add_u32 v14, s48, v26
    s_add_u32 m0, s48, 0
    s_nop 0
    buffer_load_dwordx4 v26, s[28:31], s64 offen sc1 lds
    s_add_u32 m0, s48, 4096
    s_nop 0
    buffer_load_dwordx4 v13, s[28:31], s64 offen sc1 lds
    s_add_u32 m0, s48, 8192
    s_nop 0
    buffer_load_dwordx4 v26, s[28:31], s65 offen sc1 lds
    s_add_u32 m0, s48, 12288
    s_nop 0
    buffer_load_dwordx4 v13, s[28:31], s65 offen sc1 lds
    s_add_u32 m0, s48, 16384
    s_nop 0
    buffer_load_dwordx4 v26, s[28:31], s66 offen sc1 lds
    s_add_u32 m0, s48, 20480
    s_nop 0
    buffer_load_dwordx4 v13, s[28:31], s66 offen sc1 lds
    s_add_u32 m0, s48, 24576
    s_nop 0
    buffer_load_dwordx4 v26, s[28:31], s67 offen sc1 lds
    s_add_u32 m0, s48, 28672
    s_nop 0
    buffer_load_dwordx4 v13, s[28:31], s67 offen sc1 lds
    v_lshrrev_b32 v18, 4, v2
    v_and_b32 v19, 15, v2
    v_lshlrev_b32 v19, 4, v19
    v_mul_u32_u24 v7, 272, v18
    v_add_u32 v7, v7, v19
    v_lshl_add_u32 v19, v18, 11, v19
    s_mul_i32 s42, s39, 2176
    v_add_u32 v18, s42, v7
    s_lshl_b32 s42, s72, 17
    s_lshl_b32 s43, s36, 10
    s_add_u32 s42, s42, s43
    s_lshl_b32 s43, s73, 8
    s_add_u32 s42, s42, s43
    s_lshl_b32 s43, s39, 14
    s_add_u32 s42, s42, s43
    s_add_u32 s43, s42, 0x2000
    s_mov_b32 s55, 0x4000
    s_waitcnt vmcnt(4)
L_AG0:
    ds_read_b32 v44, v14 offset:0
    ds_read_b32 v45, v14 offset:4096
    ds_read_b32 v46, v14 offset:8192
    ds_read_b32 v47, v14 offset:12288
    s_waitcnt lgkmcnt(1)
    v_max3_u32 v4, v44, v45, v46
    s_waitcnt lgkmcnt(0)
    v_max_u32 v4, v4, v47
    v_cmp_eq_u32 vcc, -1, v4
    s_nop 4
    s_cbranch_vccnz L_AR0
L_AG0X:
    s_barrier
    s_waitcnt vmcnt(0)
L_AG1:
    ds_read_b32 v48, v14 offset:16384
    ds_read_b32 v49, v14 offset:20480
    ds_read_b32 v50, v14 offset:24576
    ds_read_b32 v51, v14 offset:28672
    s_waitcnt lgkmcnt(1)
    v_max3_u32 v4, v48, v49, v50
    s_waitcnt lgkmcnt(0)
    v_max_u32 v4, v4, v51
    v_cmp_eq_u32 vcc, -1, v4
    s_nop 4
    s_cbranch_vccnz L_AR1
L_AG1X:
    s_barrier
    s_add_u32 m0, s48, 32768
    s_nop 0
    buffer_load_dwordx4 v16, s[28:31], s64 offen sc1 lds
    s_add_u32 m0, s48, 36864
    s_nop 0
    buffer_load_dwordx4 v17, s[28:31], s64 offen sc1 lds
    s_add_u32 m0, s48, 40960
    s_nop 0
    buffer_load_dwordx4 v16, s[28:31], s65 offen sc1 lds
    s_add_u32 m0, s48, 45056
    s_nop 0
    buffer_load_dwordx4 v17, s[28:31], s65 offen sc1 lds
    s_add_u32 m0, s48, 49152
    s_nop 0
    buffer_load_dwordx4 v16, s[28:31], s66 offen sc1 lds
    s_add_u32 m0, s48, 53248
    s_nop 0
    buffer_load_dwordx4 v17, s[28:31], s66 offen sc1 lds
    s_add_u32 m0, s48, 57344
    s_nop 0
    buffer_load_dwordx4 v16, s[28:31], s67 offen sc1 lds
    s_add_u32 m0, s48, 61440
    s_nop 0
    buffer_load_dwordx4 v17, s[28:31], s67 offen sc1 lds
    s_waitcnt vmcnt(6)
L_AG2:
    ds_read_b32 v52, v14 offset:32768
    ds_read_b32 v53, v14 offset:36864
    s_waitcnt lgkmcnt(0)
    v_max_u32 v4, v52, v53
    v_cmp_eq_u32 vcc, -1, v4
    s_nop 4
    s_cbranch_vccnz L_AR2
L_AG2X:
    s_barrier
    s_waitcnt vmcnt(4)
L_AG3:
    ds_read_b32 v54, v14 offset:40960
    ds_read_b32 v55, v14 offset:45056
    s_waitcnt lgkmcnt(0)
    v_max_u32 v4, v54, v55
    v_cmp_eq_u32 vcc, -1, v4
    s_nop 4
    s_cbranch_vccnz L_AR3
L_AG3X:
    s_barrier
    s_waitcnt vmcnt(2)
L_AG4:
    ds_read_b32 v56, v14 offset:49152
    ds_read_b32 v57, v14 offset:53248
    s_waitcnt lgkmcnt(0)
    v_max_u32 v4, v56, v57
    v_cmp_eq_u32 vcc, -1, v4
    s_nop 4
    s_cbranch_vccnz L_AR4
L_AG4X:
    s_barrier
    s_waitcnt vmcnt(0)
L_AG5:
    ds_read_b32 v58, v14 offset:57344
    ds_read_b32 v59, v14 offset:61440
    s_waitcnt lgkmcnt(0)
    v_max_u32 v4, v58, v59
    v_cmp_eq_u32 vcc, -1, v4
    s_nop 4
    s_cbranch_vccnz L_AR5
L_AG5X:
    s_barrier
L_AX:
    s_barrier
    ds_read_b128 v[92:95], v18 offset:0
    ds_read_b128 v[96:99], v18 offset:1088
    s_waitcnt lgkmcnt(1)
    buffer_store_dwordx4 v[92:95], v19, s[24:27], s42 offen sc1 nt
    s_waitcnt lgkmcnt(0)
    buffer_store_dwordx4 v[96:99], v19, s[24:27], s43 offen sc1 nt
    s_endpgm
L_SMK0:
    s_nop 11
    v_max3_f32 v116, v44, v45, v46
    v_max3_f32 v116, v116, v47, v48
    v_max3_f32 v116, v116, v49, v50
    v_max3_f32 v116, v116, v51, v52
    v_max3_f32 v116, v116, v53, v54
    v_max3_f32 v116, v116, v55, v56
    v_max3_f32 v116, v116, v57, v58
    v_max_f32 v116, v116, v59
    v_min3_f32 v117, v44, v45, v46
    v_min3_f32 v117, v117, v47, v48
    v_min3_f32 v117, v117, v49, v50
    v_min3_f32 v117, v117, v51, v52
    v_min3_f32 v117, v117, v53, v54
    v_min3_f32 v117, v117, v55, v56
    v_min3_f32 v117, v117, v57, v58
    v_min_f32 v117, v117, v59
    v_sub_f32 v92, v117, v44
    v_sub_f32 v93, v117, v45
    v_sub_f32 v94, v117, v46
    v_sub_f32 v95, v117, v47
    v_sub_f32 v96, v117, v48
    v_sub_f32 v97, v117, v49
    v_sub_f32 v98, v117, v50
    v_sub_f32 v99, v117, v51
    v_sub_f32 v100, v117, v52
    v_sub_f32 v101, v117, v53
    v_sub_f32 v102, v117, v54
    v_sub_f32 v103, v117, v55
    v_sub_f32 v104, v117, v56
    v_sub_f32 v105, v117, v57
    v_sub_f32 v106, v117, v58
    v_sub_f32 v107, v117, v59
    v_sub_f32 v44, v44, v116
    v_sub_f32 v45, v45, v116
    v_sub_f32 v46, v46, v116
    v_sub_f32 v47, v47, v116
    v_sub_f32 v48, v48, v116
    v_sub_f32 v49, v49, v116
    v_sub_f32 v50, v50, v116
    v_sub_f32 v51, v51, v116
    v_sub_f32 v52, v52, v116
    v_sub_f32 v53, v53, v116
    v_sub_f32 v54, v54, v116
    v_sub_f32 v55, v55, v116
    v_sub_f32 v56, v56, v116
    v_sub_f32 v57, v57, v116
    v_sub_f32 v58, v58, v116
    v_sub_f32 v59, v59, v116
    v_exp_f32 v92, v92
    v_exp_f32 v93, v93
    v_exp_f32 v94, v94
    v_exp_f32 v95, v95
    v_exp_f32 v96, v96
    v_exp_f32 v97, v97
    v_exp_f32 v98, v98
    v_exp_f32 v99, v99
    v_exp_f32 v100, v100
    v_exp_f32 v101, v101
    v_exp_f32 v102, v102
    v_exp_f32 v103, v103
    v_exp_f32 v104, v104
    v_exp_f32 v105, v105
    v_exp_f32 v106, v106
    v_exp_f32 v107, v107
    s_nop 2
    s_branch L_SMK0B
L_SMQ0:
    s_nop 11
    v_max3_f32 v116, v44, v45, v46
    v_max3_f32 v116, v116, v47, v48
    v_max3_f32 v116, v116, v49, v50
    v_max3_f32 v116, v116, v51, v52
    v_max3_f32 v116, v116, v53, v54
    v_max3_f32 v116, v116, v55, v56
    v_max3_f32 v116, v116, v57, v58
    v_max_f32 v116, v116, v59
    v_min3_f32 v117, v44, v45, v46
    v_min3_f32 v117, v117, v47, v48
    v_min3_f32 v117, v117, v49, v50
    v_min3_f32 v117, v117, v51, v52
    v_min3_f32 v117, v117, v53, v54
    v_min3_f32 v117, v117, v55, v56
    v_min3_f32 v117, v117, v57, v58
    v_min_f32 v117, v117, v59
    v_sub_f32 v92, v117, v44
    v_sub_f32 v93, v117, v45
    v_sub_f32 v94, v117, v46
    v_sub_f32 v95, v117, v47
    v_sub_f32 v96, v117, v48
    v_sub_f32 v97, v117, v49
    v_sub_f32 v98, v117, v50
    v_sub_f32 v99, v117, v51
    v_sub_f32 v100, v117, v52
    v_sub_f32 v101, v117, v53
    v_sub_f32 v102, v117, v54
    v_sub_f32 v103, v117, v55
    v_sub_f32 v104, v117, v56
    v_sub_f32 v105, v117, v57
    v_sub_f32 v106, v117, v58
    v_sub_f32 v107, v117, v59
    v_sub_f32 v44, v44, v116
    v_sub_f32 v45, v45, v116
    v_sub_f32 v46, v46, v116
    v_sub_f32 v47, v47, v116
    v_sub_f32 v48, v48, v116
    v_sub_f32 v49, v49, v116
    v_sub_f32 v50, v50, v116
    v_sub_f32 v51, v51, v116
    v_sub_f32 v52, v52, v116
    v_sub_f32 v53, v53, v116
    v_sub_f32 v54, v54, v116
    v_sub_f32 v55, v55, v116
    v_sub_f32 v56, v56, v116
    v_sub_f32 v57, v57, v116
    v_sub_f32 v58, v58, v116
    v_sub_f32 v59, v59, v116
    v_exp_f32 v92, v92
    v_exp_f32 v93, v93
    v_exp_f32 v94, v94
    v_exp_f32 v95, v95
    v_exp_f32 v96, v96
    v_exp_f32 v97, v97
    v_exp_f32 v98, v98
    v_exp_f32 v99, v99
    v_exp_f32 v100, v100
    v_exp_f32 v101, v101
    v_exp_f32 v102, v102
    v_exp_f32 v103, v103
    v_exp_f32 v104, v104
    v_exp_f32 v105, v105
    v_exp_f32 v106, v106
    v_exp_f32 v107, v107
    s_nop 2
    s_branch L_SMQ0B
L_SMQ1:
    s_nop 11
    v_max3_f32 v116, v60, v61, v62
    v_max3_f32 v116, v116, v63, v64
    v_max3_f32 v116, v116, v65, v66
    v_max3_f32 v116, v116, v67, v68
    v_max3_f32 v116, v116, v69, v70
    v_max3_f32 v116, v116, v71, v72
    v_max3_f32 v116, v116, v73, v74
    v_max_f32 v116, v116, v75
    v_min3_f32 v117, v60, v61, v62
    v_min3_f32 v117, v117, v63, v64
    v_min3_f32 v117, v117, v65, v66
    v_min3_f32 v117, v117, v67, v68
    v_min3_f32 v117, v117, v69, v70
    v_min3_f32 v117, v117, v71, v72
    v_min3_f32 v117, v117, v73, v74
    v_min_f32 v117, v117, v75
    v_sub_f32 v92, v117, v60
    v_sub_f32 v93, v117, v61
    v_sub_f32 v94, v117, v62
    v_sub_f32 v95, v117, v63
    v_sub_f32 v96, v117, v64
    v_sub_f32 v97, v117, v65
    v_sub_f32 v98, v117, v66
    v_sub_f32 v99, v117, v67
    v_sub_f32 v100, v117, v68
    v_sub_f32 v101, v117, v69
    v_sub_f32 v102, v117, v70
    v_sub_f32 v103, v117, v71
    v_sub_f32 v104, v117, v72
    v_sub_f32 v105, v117, v73
    v_sub_f32 v106, v117, v74
    v_sub_f32 v107, v117, v75
    v_sub_f32 v60, v60, v116
    v_sub_f32 v61, v61, v116
    v_sub_f32 v62, v62, v116
    v_sub_f32 v63, v63, v116
    v_sub_f32 v64, v64, v116
    v_sub_f32 v65, v65, v116
    v_sub_f32 v66, v66, v116
    v_sub_f32 v67, v67, v116
    v_sub_f32 v68, v68, v116
    v_sub_f32 v69, v69, v116
    v_sub_f32 v70, v70, v116
    v_sub_f32 v71, v71, v116
    v_sub_f32 v72, v72, v116
    v_sub_f32 v73, v73, v116
    v_sub_f32 v74, v74, v116
    v_sub_f32 v75, v75, v116
    v_exp_f32 v92, v92
    v_exp_f32 v93, v93
    v_exp_f32 v94, v94
    v_exp_f32 v95, v95
    v_exp_f32 v96, v96
    v_exp_f32 v97, v97
    v_exp_f32 v98, v98
    v_exp_f32 v99, v99
    v_exp_f32 v100, v100
    v_exp_f32 v101, v101
    v_exp_f32 v102, v102
    v_exp_f32 v103, v103
    v_exp_f32 v104, v104
    v_exp_f32 v105, v105
    v_exp_f32 v106, v106
    v_exp_f32 v107, v107
    s_nop 2
    s_branch L_SMQ1B
L_AR0:
    s_add_u32 s54, s54, 4
    s_add_u32 m0, s48, 0
    s_nop 0
    buffer_load_dwordx4 v26, s[28:31], s64 offen sc1 lds
    s_add_u32 m0, s48, 4096
    s_nop 0
    buffer_load_dwordx4 v13, s[28:31], s64 offen sc1 lds
    s_add_u32 m0, s48, 8192
    s_nop 0
    buffer_load_dwordx4 v26, s[28:31], s65 offen sc1 lds
    s_add_u32 m0, s48, 12288
    s_nop 0
    buffer_load_dwordx4 v13, s[28:31], s65 offen sc1 lds
    s_waitcnt vmcnt(0)
    s_sub_u32 s55, s55, 1
    s_cbranch_scc1 L_AG0X
    s_branch L_AG0
L_AR1:
    s_add_u32 s54, s54, 4
    s_add_u32 m0, s48, 16384
    s_nop 0
    buffer_load_dwordx4 v26, s[28:31], s66 offen sc1 lds
    s_add_u32 m0, s48, 20480
    s_nop 0
    buffer_load_dwordx4 v13, s[28:31], s66 offen sc1 lds
    s_add_u32 m0, s48, 24576
    s_nop 0
    buffer_load_dwordx4 v26, s[28:31], s67 offen sc1 lds
    s_add_u32 m0, s48, 28672
    s_nop 0
    buffer_load_dwordx4 v13, s[28:31], s67 offen sc1 lds
    s_waitcnt vmcnt(0)
    s_sub_u32 s55, s55, 1
    s_cbranch_scc1 L_AG1X
    s_branch L_AG1
L_AR2:
    s_add_u32 s54, s54, 4
    s_add_u32 m0, s48, 32768
    s_nop 0
    buffer_load_dwordx4 v16, s[28:31], s64 offen sc1 lds
    s_add_u32 m0, s48, 36864
    s_nop 0
    buffer_load_dwordx4 v17, s[28:31], s64 offen sc1 lds
    s_waitcnt vmcnt(0)
    s_sub_u32 s55, s55, 1
    s_cbranch_scc1 L_AG2X
    s_branch L_AG2
L_AR3:
    s_add_u32 s54, s54, 4
    s_add_u32 m0, s48, 40960
    s_nop 0
    buffer_load_dwordx4 v16, s[28:31], s65 offen sc1 lds
    s_add_u32 m0, s48, 45056
    s_nop 0
    buffer_load_dwordx4 v17, s[28:31], s65 offen sc1 lds
    s_waitcnt vmcnt(0)
    s_sub_u32 s55, s55, 1
    s_cbranch_scc1 L_AG3X
    s_branch L_AG3
L_AR4:
    s_add_u32 s54, s54, 4
    s_add_u32 m0, s48, 49152
    s_nop 0
    buffer_load_dwordx4 v16, s[28:31], s66 offen sc1 lds
    s_add_u32 m0, s48, 53248
    s_nop 0
    buffer_load_dwordx4 v17, s[28:31], s66 offen sc1 lds
    s_waitcnt vmcnt(0)
    s_sub_u32 s55, s55, 1
    s_cbranch_scc1 L_AG4X
    s_branch L_AG4
L_AR5:
    s_add_u32 s54, s54, 4
    s_add_u32 m0, s48, 57344
    s_nop 0
    buffer_load_dwordx4 v16, s[28:31], s67 offen sc1 lds
    s_add_u32 m0, s48, 61440
    s_nop 0
    buffer_load_dwordx4 v17, s[28:31], s67 offen sc1 lds
    s_waitcnt vmcnt(0)
    s_sub_u32 s55, s55, 1
    s_cbranch_scc1 L_AG5X
    s_branch L_AG5
L_ROLE1:
    s_setprio 0
    s_mov_b32 s50, 0x42700000
    s_mov_b32 s51, 0x3fb8aa3b
    s_lshl_b32 s42, s36, 5
    s_lshl_b32 s43, s38, 2
    s_add_u32 s43, s42, s43
    s_add_u32 s43, s43, s40
    s_lshl_b32 s76, s43, 14
    s_lshl_b32 s77, s43, 11
    s_add_u32 s77, s77, 0x100000
    s_lshl_b32 s42, s36, 6
    s_lshl_b32 s43, s37, 2
    s_add_u32 s43, s42, s43
    s_add_u32 s43, s43, s40
    s_lshl_b32 s49, s43, 15
    s_lshl_b32 s43, s38, 12
    s_add_u32 s49, s49, s43
    s_add_u32 s49, s49, 0x200000
    s_add_u32 s43, s2, 1
    s_and_b32 s43, s43, 3
    s_lshl_b32 s43, s43, 3
    s_lshr_b32 s44, s2, 5
    s_add_u32 s72, s43, s44
    s_bfe_u32 s73, s2, 0x20003
    s_lshl_b32 s74, s73, 1
    s_add_u32 s74, s74, s72
    s_lshl_b32 s43, s72, 1
    s_add_u32 s43, s43, s42
    s_lshl_b32 s75, s43, 15
    s_add_u32 s75, s75, 0x200000
    s_lshl_b32 s42, s37, 10
    s_add_u32 s52, s42, s76
    s_lshl_b32 s42, s37, 7
    s_add_u32 s53, s42, s77
    v_mov_b32 v124, -1
    v_mov_b32 v125, -1
    v_mov_b32 v126, -1
    v_mov_b32 v127, -1
    s_mov_b32 s54, 0
    s_lshl_b32 s42, s36, 4
    s_add_u32 s43, s42, s37
    s_lshl_b32 s43, s43, 3
    s_add_u32 s43, s43, s38
    s_lshl_b32 s43, s43, 5
    s_add_u32 s43, s43, s40
    s_lshl_b32 s3, s43, 2
    s_add_u32 s3, s3, 0x140000
    s_lshr_b32 s43, s72, 1
    s_add_u32 s43, s43, s42
    s_lshl_b32 s4, s43, 10
    s_add_u32 s4, s4, 0x140000
    v_and_b32 v7, 31, v2
    v_bfe_u32 v8, v2, 1, 3
    v_xor_b32 v8, v8, v3
    v_lshlrev_b32 v8, 4, v8
    v_lshl_add_u32 v8, v7, 7, v8
    s_lshl_b32 s44, s40, 12
    v_add_u32 v8, s44, v8
    v_xor_b32 v16, 0, v8
    v_xor_b32 v17, 32, v8
    v_xor_b32 v18, 64, v8
    v_xor_b32 v19, 96, v8
    v_bfe_u32 v7, v2, 2, 2
    v_lshl_add_u32 v8, v3, 3, v7
    v_lshlrev_b32 v8, 7, v8
    v_bfe_u32 v9, v2, 3, 1
    v_lshl_add_u32 v8, v9, 6, v8
    v_bfe_u32 v9, v2, 4, 1
    v_lshl_add_u32 v8, v9, 5, v8
    v_and_b32 v10, 3, v2
    v_lshl_add_u32 v20, v10, 3, v8
    v_xor_b32 v23, 64, v20
    v_add_u32 v21, 0x10000, v20
    v_add_u32 v22, 0x20000, v20
    v_add_u32 v24, 0x10000, v23
    v_add_u32 v25, 0x20000, v23
    v_lshl_add_u32 v8, v3, 2, v7
    v_lshlrev_b32 v8, 5, v8
    v_lshl_add_u32 v8, v9, 4, v8
    v_bfe_u32 v10, v2, 1, 1
    v_lshl_add_u32 v8, v10, 3, v8
    v_and_b32 v10, 1, v2
    v_lshl_add_u32 v8, v10, 9, v8
    v_add_u32 v122, 155648, v8
    s_lshl_b32 s44, s40, 12
    v_and_b32 v7, 31, v2
    v_bfe_u32 v8, v2, 1, 2
    v_bfe_u32 v9, v2, 4, 1
    v_lshlrev_b32 v10, 1, v9
    v_xor_b32 v8, v8, v10
    v_lshlrev_b32 v8, 4, v8
    v_lshl_add_u32 v8, v7, 6, v8
    v_lshl_add_u32 v8, v3, 11, v8
    v_add_u32 v119, s44, v8
    v_add_u32 v118, s44, v26
    v_bfe_u32 v8, v2, 2, 2
    v_lshl_add_u32 v8, v3, 2, v8
    v_lshl_add_u32 v7, v9, 4, v8
    v_lshrrev_b32 v8, 1, v8
    v_xor_b32 v8, v8, v10
    v_bfe_u32 v10, v2, 1, 1
    v_xor_b32 v8, v8, v10
    v_lshlrev_b32 v8, 4, v8
    v_lshl_add_u32 v8, v7, 6, v8
    v_and_b32 v10, 1, v2
    v_lshl_add_u32 v8, v10, 3, v8
    s_lshr_b32 s44, s40, 1
    s_lshl_b32 s44, s44, 14
    s_and_b32 s45, s40, 1
    s_lshl_b32 s43, s45, 11
    s_add_u32 s43, s43, s44
    v_add_u32 v120, s43, v8
    v_and_b32 v8, 15, v2
    v_lshl_add_u32 v8, v3, 5, v8
    v_lshlrev_b32 v8, 4, v8
    v_lshl_add_u32 v8, v9, 10, v8
    s_lshr_b32 s44, s44, 3
    s_lshl_b32 s45, s45, 8
    s_add_u32 s44, s44, s45
    v_add_u32 v121, s44, v8
    v_lshlrev_b32 v123, 2, v2
    s_add_u32 s43, s41, 0
    s_and_b32 s43, s43, 7
    s_lshl_b32 s56, s43, 7
    s_add_u32 s56, s56, s46
    s_mul_i32 s64, s43, 196608
    s_add_u32 s64, s64, s47
    s_add_u32 s43, s41, 1
    s_and_b32 s43, s43, 7
    s_lshl_b32 s57, s43, 7
    s_add_u32 s57, s57, s46
    s_mul_i32 s65, s43, 196608
    s_add_u32 s65, s65, s47
    s_add_u32 s43, s41, 2
    s_and_b32 s43, s43, 7
    s_lshl_b32 s58, s43, 7
    s_add_u32 s58, s58, s46
    s_mul_i32 s66, s43, 196608
    s_add_u32 s66, s66, s47
    s_add_u32 s43, s41, 3
    s_and_b32 s43, s43, 7
    s_lshl_b32 s59, s43, 7
    s_add_u32 s59, s59, s46
    s_mul_i32 s67, s43, 196608
    s_add_u32 s67, s67, s47
    s_add_u32 s43, s41, 4
    s_and_b32 s43, s43, 7
    s_lshl_b32 s60, s43, 7
    s_add_u32 s60, s60, s46
    s_mul_i32 s68, s43, 196608
    s_add_u32 s68, s68, s47
    s_add_u32 s43, s41, 5
    s_and_b32 s43, s43, 7
    s_lshl_b32 s61, s43, 7
    s_add_u32 s61, s61, s46
    s_mul_i32 s69, s43, 196608
    s_add_u32 s69, s69, s47
    s_add_u32 s43, s41, 6
    s_and_b32 s43, s43, 7
    s_lshl_b32 s62, s43, 7
    s_add_u32 s62, s62, s46
    s_mul_i32 s70, s43, 196608
    s_add_u32 s70, s70, s47
    s_add_u32 s43, s41, 7
    s_and_b32 s43, s43, 7
    s_lshl_b32 s63, s43, 7
    s_add_u32 s63, s63, s46
    s_mul_i32 s71, s43, 196608
    s_add_u32 s71, s71, s47
    s_add_u32 s56, s74, 0
    s_and_b32 s56, s56, 7
    s_add_u32 s57, s74, 1
    s_and_b32 s57, s57, 7
    s_add_u32 s58, s74, 2
    s_and_b32 s58, s58, 7
    s_add_u32 s59, s74, 3
    s_and_b32 s59, s59, 7
    s_add_u32 s60, s74, 4
    s_and_b32 s60, s60, 7
    s_add_u32 s61, s74, 5
    s_and_b32 s61, s61, 7
    s_add_u32 s62, s74, 6
    s_and_b32 s62, s62, 7
    s_add_u32 s63, s74, 7
    s_and_b32 s63, s63, 7
    s_barrier
    ds_read_b64_tr_b16 v[76:77], v122 offset:0
    ds_read_b64_tr_b16 v[78:79], v122 offset:256
    ds_read_b64_tr_b16 v[80:81], v122 offset:1024
    ds_read_b64_tr_b16 v[82:83], v122 offset:1280
    v_bfe_u32 v6, v2, 2, 1
    v_cmp_eq_u32 vcc, 0, v6
    s_waitcnt lgkmcnt(1)
    v_lshlrev_b32 v7, 16, v80
    v_and_b32 v8, 0xffff0000, v80
    v_mul_f32 v7, s51, v7
    v_mul_f32 v8, s51, v8
    v_cvt_pk_bf16_f32 v80, v7, v8
    v_lshlrev_b32 v7, 16, v81
    v_and_b32 v8, 0xffff0000, v81
    v_mul_f32 v7, s51, v7
    v_mul_f32 v8, s51, v8
    v_cvt_pk_bf16_f32 v81, v7, v8
    s_waitcnt lgkmcnt(0)
    v_lshlrev_b32 v7, 16, v82
    v_and_b32 v8, 0xffff0000, v82
    v_mul_f32 v7, s51, v7
    v_mul_f32 v8, s51, v8
    v_cvt_pk_bf16_f32 v82, v7, v8
    v_lshlrev_b32 v7, 16, v83
    v_and_b32 v8, 0xffff0000, v83
    v_mul_f32 v7, s51, v7
    v_mul_f32 v8, s51, v8
    v_cvt_pk_bf16_f32 v83, v7, v8
    v_cndmask_b32 v36, 0, v80, vcc
    v_cndmask_b32 v40, v80, 0, vcc
    v_cndmask_b32 v37, 0, v81, vcc
    v_cndmask_b32 v41, v81, 0, vcc
    v_cndmask_b32 v38, 0, v82, vcc
    v_cndmask_b32 v42, v82, 0, vcc
    v_cndmask_b32 v39, 0, v83, vcc
    v_cndmask_b32 v43, v83, 0, vcc
    s_barrier
    ds_read_b128 a[0:3], v16 offset:0
    ds_read_b64_tr_b16 a[32:33], v23 offset:16384
    ds_read_b64_tr_b16 a[34:35], v23 offset:16896
    ds_read_b64_tr_b16 a[36:37], v23 offset:24576
    ds_read_b64_tr_b16 a[38:39], v23 offset:25088
    ds_read_b128 a[4:7], v17 offset:0
    ds_read_b64_tr_b16 a[40:41], v23 offset:18432
    ds_read_b64_tr_b16 a[42:43], v23 offset:18944
    ds_read_b64_tr_b16 a[44:45], v23 offset:26624
    ds_read_b64_tr_b16 a[46:47], v23 offset:27136
    s_waitcnt lgkmcnt(7)
    v_mfma_f32_32x32x16_bf16 v[60:75], a[32:35], a[0:3], 0
    ds_read_b128 a[8:11], v18 offset:0
    ds_read_b64_tr_b16 a[48:49], v23 offset:20480
    ds_read_b64_tr_b16 a[50:51], v23 offset:20992
    s_waitcnt lgkmcnt(8)
    v_mfma_f32_32x32x16_bf16 v[44:59], a[0:3], a[36:39], 0
    ds_read_b64_tr_b16 a[52:53], v23 offset:28672
    ds_read_b64_tr_b16 a[54:55], v23 offset:29184
    s_waitcnt lgkmcnt(7)
    v_mfma_f32_32x32x16_bf16 v[60:75], a[40:43], a[4:7], v[60:75]
    ds_read_b128 a[12:15], v19 offset:0
    ds_read_b64_tr_b16 a[56:57], v23 offset:22528
    ds_read_b64_tr_b16 a[58:59], v23 offset:23040
    s_waitcnt lgkmcnt(8)
    v_mfma_f32_32x32x16_bf16 v[44:59], a[4:7], a[44:47], v[44:59]
    ds_read_b64_tr_b16 a[60:61], v23 offset:30720
    ds_read_b64_tr_b16 a[62:63], v23 offset:31232
    buffer_store_dwordx4 v[124:127], v26, s[28:31], s52 offen sc1
    s_mov_b64 exec, 0xff
    buffer_store_dwordx4 v[124:127], v26, s[28:31], s53 offen sc1
    s_mov_b64 exec, -1
    s_barrier
    s_waitcnt lgkmcnt(7)
    v_mfma_f32_32x32x16_bf16 v[60:75], a[48:51], a[8:11], v[60:75]
    ds_read_b128 a[16:19], v16 offset:32768
    ds_read_b64_tr_b16 a[64:65], v23 offset:49152
    ds_read_b64_tr_b16 a[66:67], v23 offset:49664
    s_waitcnt lgkmcnt(8)
    v_mfma_f32_32x32x16_bf16 v[44:59], a[8:11], a[52:55], v[44:59]
    ds_read_b64_tr_b16 a[68:69], v23 offset:57344
    ds_read_b64_tr_b16 a[70:71], v23 offset:57856
    s_waitcnt lgkmcnt(7)
    v_mfma_f32_32x32x16_bf16 v[60:75], a[56:59], a[12:15], v[60:75]
    ds_read_b128 a[20:23], v17 offset:32768
    ds_read_b64_tr_b16 a[72:73], v23 offset:51200
    ds_read_b64_tr_b16 a[74:75], v23 offset:51712
    s_waitcnt lgkmcnt(8)
    v_mfma_f32_32x32x16_bf16 v[44:59], a[12:15], a[60:63], v[44:59]
    ds_read_b64_tr_b16 a[76:77], v23 offset:59392
    ds_read_b64_tr_b16 a[78:79], v23 offset:59904
    s_waitcnt lgkmcnt(7)
    v_mfma_f32_32x32x16_bf16 v[60:75], a[64:67], a[16:19], v[60:75]
    ds_read_b128 a[24:27], v18 offset:32768
    ds_read_b64_tr_b16 a[80:81], v23 offset:53248
    ds_read_b64_tr_b16 a[82:83], v23 offset:53760
    s_waitcnt lgkmcnt(8)
    v_mfma_f32_32x32x16_bf16 v[44:59], a[16:19], a[68:71], v[44:59]
    ds_read_b64_tr_b16 a[84:85], v23 offset:61440
    ds_read_b64_tr_b16 a[86:87], v23 offset:61952
    s_waitcnt lgkmcnt(7)
    v_mfma_f32_32x32x16_bf16 v[60:75], a[72:75], a[20:23], v[60:75]
    ds_read_b128 a[28:31], v19 offset:32768
    ds_read_b64_tr_b16 a[88:89], v23 offset:55296
    ds_read_b64_tr_b16 a[90:91], v23 offset:55808
    s_waitcnt lgkmcnt(8)
    v_mfma_f32_32x32x16_bf16 v[44:59], a[20:23], a[76:79], v[44:59]
    ds_read_b64_tr_b16 a[92:93], v23 offset:63488
    ds_read_b64_tr_b16 a[94:95], v23 offset:64000
    buffer_store_dwordx4 v[124:127], v26, s[28:31], s49 offen offset:0 sc1
    buffer_store_dwordx4 v[124:127], v26, s[28:31], s49 offen offset:1024 sc1
    s_barrier
    v_add_u32 v16, 0x10000, v16
    v_add_u32 v17, 0x10000, v17
    v_add_u32 v18, 0x10000, v18
    v_add_u32 v19, 0x10000, v19
    s_waitcnt lgkmcnt(7)
    v_mfma_f32_32x32x16_bf16 v[60:75], a[80:83], a[24:27], v[60:75]
    ds_read_b128 a[0:3], v16 offset:0
    ds_read_b64_tr_b16 a[32:33], v24 offset:16384
    ds_read_b64_tr_b16 a[34:35], v24 offset:16896
    s_waitcnt lgkmcnt(8)
    v_mfma_f32_32x32x16_bf16 v[44:59], a[24:27], a[84:87], v[44:59]
    ds_read_b64_tr_b16 a[36:37], v24 offset:24576
    ds_read_b64_tr_b16 a[38:39], v24 offset:25088
    s_waitcnt lgkmcnt(7)
    v_mfma_f32_32x32x16_bf16 v[60:75], a[88:91], a[28:31], v[60:75]
    ds_read_b128 a[4:7], v17 offset:0
    ds_read_b64_tr_b16 a[40:41], v24 offset:18432
    ds_read_b64_tr_b16 a[42:43], v24 offset:18944
    s_waitcnt lgkmcnt(8)
    v_mfma_f32_32x32x16_bf16 v[44:59], a[28:31], a[92:95], v[44:59]
    ds_read_b64_tr_b16 a[44:45], v24 offset:26624
    ds_read_b64_tr_b16 a[46:47], v24 offset:27136
    s_waitcnt lgkmcnt(7)
    v_mfma_f32_32x32x16_bf16 v[60:75], a[32:35], a[0:3], v[60:75]
    ds_read_b128 a[8:11], v18 offset:0
    ds_read_b64_tr_b16 a[48:49], v24 offset:20480
    ds_read_b64_tr_b16 a[50:51], v24 offset:20992
    s_waitcnt lgkmcnt(8)
    v_mfma_f32_32x32x16_bf16 v[44:59], a[0:3], a[36:39], v[44:59]
    ds_read_b64_tr_b16 a[52:53], v24 offset:28672
    ds_read_b64_tr_b16 a[54:55], v24 offset:29184
    s_waitcnt lgkmcnt(7)
    v_mfma_f32_32x32x16_bf16 v[60:75], a[40:43], a[4:7], v[60:75]
    ds_read_b128 a[12:15], v19 offset:0
    ds_read_b64_tr_b16 a[56:57], v24 offset:22528
    ds_read_b64_tr_b16 a[58:59], v24 offset:23040
    s_waitcnt lgkmcnt(8)
    v_mfma_f32_32x32x16_bf16 v[44:59], a[4:7], a[44:47], v[44:59]
    ds_read_b64_tr_b16 a[60:61], v24 offset:30720
    ds_read_b64_tr_b16 a[62:63], v24 offset:31232
    buffer_store_dwordx4 v[124:127], v26, s[28:31], s49 offen offset:2048 sc1
    buffer_store_dwordx4 v[124:127], v26, s[28:31], s49 offen offset:3072 sc1
    s_barrier
    s_waitcnt lgkmcnt(7)
    v_mfma_f32_32x32x16_bf16 v[60:75], a[48:51], a[8:11], v[60:75]
    ds_read_b128 a[16:19], v16 offset:32768
    ds_read_b64_tr_b16 a[64:65], v24 offset:49152
    ds_read_b64_tr_b16 a[66:67], v24 offset:49664
    s_waitcnt lgkmcnt(8)
    v_mfma_f32_32x32x16_bf16 v[44:59], a[8:11], a[52:55], v[44:59]
    ds_read_b64_tr_b16 a[68:69], v24 offset:57344
    ds_read_b64_tr_b16 a[70:71], v24 offset:57856
    s_waitcnt lgkmcnt(7)
    v_mfma_f32_32x32x16_bf16 v[60:75], a[56:59], a[12:15], v[60:75]
    ds_read_b128 a[20:23], v17 offset:32768
    ds_read_b64_tr_b16 a[72:73], v24 offset:51200
    ds_read_b64_tr_b16 a[74:75], v24 offset:51712
    s_waitcnt lgkmcnt(8)
    v_mfma_f32_32x32x16_bf16 v[44:59], a[12:15], a[60:63], v[44:59]
    ds_read_b64_tr_b16 a[76:77], v24 offset:59392
    ds_read_b64_tr_b16 a[78:79], v24 offset:59904
    s_waitcnt lgkmcnt(7)
    v_mfma_f32_32x32x16_bf16 v[60:75], a[64:67], a[16:19], v[60:75]
    ds_read_b128 a[24:27], v18 offset:32768
    ds_read_b64_tr_b16 a[80:81], v24 offset:53248
    ds_read_b64_tr_b16 a[82:83], v24 offset:53760
    s_waitcnt lgkmcnt(8)
    v_mfma_f32_32x32x16_bf16 v[44:59], a[16:19], a[68:71], v[44:59]
    ds_read_b64_tr_b16 a[84:85], v24 offset:61440
    ds_read_b64_tr_b16 a[86:87], v24 offset:61952
    s_waitcnt lgkmcnt(7)
    v_mfma_f32_32x32x16_bf16 v[60:75], a[72:75], a[20:23], v[60:75]
    ds_read_b128 a[28:31], v19 offset:32768
    ds_read_b64_tr_b16 a[88:89], v24 offset:55296
    ds_read_b64_tr_b16 a[90:91], v24 offset:55808
    s_waitcnt lgkmcnt(8)
    v_mfma_f32_32x32x16_bf16 v[44:59], a[20:23], a[76:79], v[44:59]
    ds_read_b64_tr_b16 a[92:93], v24 offset:63488
    ds_read_b64_tr_b16 a[94:95], v24 offset:64000
    s_barrier
    v_add_u32 v16, 0x10000, v16
    v_add_u32 v17, 0x10000, v17
    v_add_u32 v18, 0x10000, v18
    v_add_u32 v19, 0x10000, v19
    s_waitcnt lgkmcnt(7)
    v_mfma_f32_32x32x16_bf16 v[60:75], a[80:83], a[24:27], v[60:75]
    ds_read_b128 a[0:3], v16 offset:0
    ds_read_b64_tr_b16 a[32:33], v25 offset:16384
    ds_read_b64_tr_b16 a[34:35], v25 offset:16896
    s_waitcnt lgkmcnt(8)
    v_mfma_f32_32x32x16_bf16 v[44:59], a[24:27], a[84:87], v[44:59]
    ds_read_b64_tr_b16 a[36:37], v25 offset:24576
    ds_read_b64_tr_b16 a[38:39], v25 offset:25088
    s_waitcnt lgkmcnt(7)
    v_mfma_f32_32x32x16_bf16 v[60:75], a[88:91], a[28:31], v[60:75]
    ds_read_b128 a[4:7], v17 offset:0
    ds_read_b64_tr_b16 a[40:41], v25 offset:18432
    ds_read_b64_tr_b16 a[42:43], v25 offset:18944
    s_waitcnt lgkmcnt(8)
    v_mfma_f32_32x32x16_bf16 v[44:59], a[28:31], a[92:95], v[44:59]
    ds_read_b64_tr_b16 a[44:45], v25 offset:26624
    ds_read_b64_tr_b16 a[46:47], v25 offset:27136
    s_waitcnt lgkmcnt(7)
    v_mfma_f32_32x32x16_bf16 v[60:75], a[32:35], a[0:3], v[60:75]
    ds_read_b128 a[8:11], v18 offset:0
    ds_read_b64_tr_b16 a[48:49], v25 offset:20480
    ds_read_b64_tr_b16 a[50:51], v25 offset:20992
    s_waitcnt lgkmcnt(8)
    v_mfma_f32_32x32x16_bf16 v[44:59], a[0:3], a[36:39], v[44:59]
    ds_read_b64_tr_b16 a[52:53], v25 offset:28672
    ds_read_b64_tr_b16 a[54:55], v25 offset:29184
    s_waitcnt lgkmcnt(7)
    v_mfma_f32_32x32x16_bf16 v[60:75], a[40:43], a[4:7], v[60:75]
    ds_read_b128 a[12:15], v19 offset:0
    ds_read_b64_tr_b16 a[56:57], v25 offset:22528
    ds_read_b64_tr_b16 a[58:59], v25 offset:23040
    s_waitcnt lgkmcnt(8)
    v_mfma_f32_32x32x16_bf16 v[44:59], a[4:7], a[44:47], v[44:59]
    ds_read_b64_tr_b16 a[60:61], v25 offset:30720
    ds_read_b64_tr_b16 a[62:63], v25 offset:31232
    s_waitcnt vmcnt(0)
    s_barrier
    v_add_u32 v16, 0xfffe0000, v16
    v_add_u32 v17, 0xfffe0000, v17
    v_add_u32 v18, 0xfffe0000, v18
    v_add_u32 v19, 0xfffe0000, v19
    s_waitcnt lgkmcnt(7)
    v_mfma_f32_32x32x16_bf16 v[60:75], a[48:51], a[8:11], v[60:75]
    ds_read_b128 a[16:19], v16 offset:0
    ds_read_b64_tr_b16 a[64:65], v23 offset:16384
    ds_read_b64_tr_b16 a[66:67], v23 offset:16896
    s_waitcnt lgkmcnt(8)
    v_mfma_f32_32x32x16_bf16 v[44:59], a[8:11], a[52:55], v[44:59]
    ds_read_b64_tr_b16 a[68:69], v23 offset:24576
    ds_read_b64_tr_b16 a[70:71], v23 offset:25088
    s_waitcnt lgkmcnt(7)
    v_mfma_f32_32x32x16_bf16 v[60:75], a[56:59], a[12:15], v[60:75]
    ds_read_b128 a[20:23], v17 offset:0
    ds_read_b64_tr_b16 a[72:73], v23 offset:18432
    ds_read_b64_tr_b16 a[74:75], v23 offset:18944
    s_waitcnt lgkmcnt(8)
    v_mfma_f32_32x32x16_bf16 v[44:59], a[12:15], a[60:63], v[44:59]
    ds_read_b64_tr_b16 a[76:77], v23 offset:26624
    ds_read_b64_tr_b16 a[78:79], v23 offset:27136
    s_waitcnt lgkmcnt(7)
    v_mfma_f32_32x32x16_bf16 v[60:75], a[64:67], a[16:19], v[60:75]
    ds_read_b128 a[24:27], v18 offset:0
    ds_read_b64_tr_b16 a[80:81], v23 offset:20480
    ds_read_b64_tr_b16 a[82:83], v23 offset:20992
    s_waitcnt lgkmcnt(8)
    v_mfma_f32_32x32x16_bf16 v[44:59], a[16:19], a[68:71], v[44:59]
    ds_read_b64_tr_b16 a[84:85], v23 offset:28672
    ds_read_b64_tr_b16 a[86:87], v23 offset:29184
    s_waitcnt lgkmcnt(7)
    v_mfma_f32_32x32x16_bf16 v[60:75], a[72:75], a[20:23], v[60:75]
    ds_read_b128 a[28:31], v19 offset:0
    ds_read_b64_tr_b16 a[88:89], v23 offset:22528
    ds_read_b64_tr_b16 a[90:91], v23 offset:23040
    s_waitcnt lgkmcnt(8)
    v_mfma_f32_32x32x16_bf16 v[44:59], a[20:23], a[76:79], v[44:59]
    ds_read_b64_tr_b16 a[92:93], v23 offset:30720
    ds_read_b64_tr_b16 a[94:95], v23 offset:31232
    s_cmp_eq_u32 s39, 4
    s_cbranch_scc0 L_NOFLAG1
    s_and_b32 s44, s2, 0xfc
    v_mov_b32 v10, 0
    v_mov_b32 v11, 1
    s_mov_b64 exec, 1
    buffer_atomic_add v11, v10, s[32:35], s44 offen
    s_mov_b64 exec, -1
L_NOFLAG1:
    s_barrier
    s_waitcnt lgkmcnt(7)
    v_mfma_f32_32x32x16_bf16 v[60:75], a[80:83], a[24:27], v[60:75]
    ds_read_b128 a[0:3], v16 offset:32768
    ds_read_b64_tr_b16 a[32:33], v23 offset:49152
    ds_read_b64_tr_b16 a[34:35], v23 offset:49664
    s_waitcnt lgkmcnt(8)
    v_mfma_f32_32x32x16_bf16 v[44:59], a[24:27], a[84:87], v[44:59]
    ds_read_b64_tr_b16 a[36:37], v23 offset:57344
    ds_read_b64_tr_b16 a[38:39], v23 offset:57856
    s_waitcnt lgkmcnt(7)
    v_mfma_f32_32x32x16_bf16 v[60:75], a[88:91], a[28:31], v[60:75]
    ds_read_b128 a[4:7], v17 offset:32768
    ds_read_b64_tr_b16 a[40:41], v23 offset:51200
    ds_read_b64_tr_b16 a[42:43], v23 offset:51712
    s_waitcnt lgkmcnt(8)
    v_mfma_f32_32x32x16_bf16 v[44:59], a[28:31], a[92:95], v[44:59]
    ds_read_b64_tr_b16 a[44:45], v23 offset:59392
    ds_read_b64_tr_b16 a[46:47], v23 offset:59904
    s_waitcnt lgkmcnt(7)
    v_mfma_f32_32x32x16_bf16 v[60:75], a[32:35], a[0:3], v[60:75]
    ds_read_b128 a[8:11], v18 offset:32768
    ds_read_b64_tr_b16 a[48:49], v23 offset:53248
    ds_read_b64_tr_b16 a[50:51], v23 offset:53760
    s_waitcnt lgkmcnt(8)
    v_mfma_f32_32x32x16_bf16 v[44:59], a[0:3], a[36:39], v[44:59]
    ds_read_b64_tr_b16 a[52:53], v23 offset:61440
    ds_read_b64_tr_b16 a[54:55], v23 offset:61952
    s_waitcnt lgkmcnt(7)
    v_mfma_f32_32x32x16_bf16 v[60:75], a[40:43], a[4:7], v[60:75]
    ds_read_b128 a[12:15], v19 offset:32768
    ds_read_b64_tr_b16 a[56:57], v23 offset:55296
    ds_read_b64_tr_b16 a[58:59], v23 offset:55808
    s_waitcnt lgkmcnt(8)
    v_mfma_f32_32x32x16_bf16 v[44:59], a[4:7], a[44:47], v[44:59]
    ds_read_b64_tr_b16 a[60:61], v23 offset:63488
    ds_read_b64_tr_b16 a[62:63], v23 offset:64000
    s_barrier
    v_add_u32 v16, 0x10000, v16
    v_add_u32 v17, 0x10000, v17
    v_add_u32 v18, 0x10000, v18
    v_add_u32 v19, 0x10000, v19
    s_waitcnt lgkmcnt(7)
    v_mfma_f32_32x32x16_bf16 v[60:75], a[48:51], a[8:11], v[60:75]
    ds_read_b128 a[16:19], v16 offset:0
    ds_read_b64_tr_b16 a[64:65], v24 offset:16384
    ds_read_b64_tr_b16 a[66:67], v24 offset:16896
    s_waitcnt lgkmcnt(8)
    v_mfma_f32_32x32x16_bf16 v[44:59], a[8:11], a[52:55], v[44:59]
    ds_read_b64_tr_b16 a[68:69], v24 offset:24576
    ds_read_b64_tr_b16 a[70:71], v24 offset:25088
    s_waitcnt lgkmcnt(7)
    v_mfma_f32_32x32x16_bf16 v[60:75], a[56:59], a[12:15], v[60:75]
    ds_read_b128 a[20:23], v17 offset:0
    ds_read_b64_tr_b16 a[72:73], v24 offset:18432
    ds_read_b64_tr_b16 a[74:75], v24 offset:18944
    s_waitcnt lgkmcnt(8)
    v_mfma_f32_32x32x16_bf16 v[44:59], a[12:15], a[60:63], v[44:59]
    ds_read_b64_tr_b16 a[76:77], v24 offset:26624
    ds_read_b64_tr_b16 a[78:79], v24 offset:27136
    s_waitcnt lgkmcnt(7)
    v_mfma_f32_32x32x16_bf16 v[60:75], a[64:67], a[16:19], v[60:75]
    ds_read_b128 a[24:27], v18 offset:0
    ds_read_b64_tr_b16 a[80:81], v24 offset:20480
    ds_read_b64_tr_b16 a[82:83], v24 offset:20992
    s_waitcnt lgkmcnt(8)
    v_mfma_f32_32x32x16_bf16 v[44:59], a[16:19], a[68:71], v[44:59]
    ds_read_b64_tr_b16 a[84:85], v24 offset:28672
    ds_read_b64_tr_b16 a[86:87], v24 offset:29184
    s_waitcnt lgkmcnt(7)
    v_mfma_f32_32x32x16_bf16 v[60:75], a[72:75], a[20:23], v[60:75]
    ds_read_b128 a[28:31], v19 offset:0
    ds_read_b64_tr_b16 a[88:89], v24 offset:22528
    ds_read_b64_tr_b16 a[90:91], v24 offset:23040
    s_waitcnt lgkmcnt(8)
    v_mfma_f32_32x32x16_bf16 v[44:59], a[20:23], a[76:79], v[44:59]
    ds_read_b64_tr_b16 a[92:93], v24 offset:30720
    ds_read_b64_tr_b16 a[94:95], v24 offset:31232
    s_waitcnt lgkmcnt(7)
    v_mfma_f32_32x32x16_bf16 v[60:75], a[80:83], a[24:27], v[60:75]
    s_waitcnt lgkmcnt(5)
    v_mfma_f32_32x32x16_bf16 v[44:59], a[24:27], a[84:87], v[44:59]
    s_waitcnt lgkmcnt(2)
    v_mfma_f32_32x32x16_bf16 v[60:75], a[88:91], a[28:31], v[60:75]
    s_waitcnt lgkmcnt(0)
    v_mfma_f32_32x32x16_bf16 v[44:59], a[28:31], a[92:95], v[44:59]
    s_nop 9
    v_cvt_pk_bf16_f32 v4, v60, v61
    v_cvt_pk_bf16_f32 v5, v62, v63
    v_cvt_pk_bf16_f32 v6, v64, v65
    v_cvt_pk_bf16_f32 v7, v66, v67
    v_cvt_pk_bf16_f32 v8, v68, v69
    v_cvt_pk_bf16_f32 v9, v70, v71
    v_cvt_pk_bf16_f32 v10, v72, v73
    v_cvt_pk_bf16_f32 v11, v74, v75
    v_mfma_f32_32x32x16_bf16 v[60:75], v[36:39], v[4:7], 0
    s_nop 0
    v_mfma_f32_32x32x16_bf16 v[60:75], v[40:43], v[8:11], v[60:75]
    s_barrier
    v_cvt_pk_bf16_f32 v76, v44, v45
    v_cvt_pk_bf16_f32 v77, v46, v47
    v_cvt_pk_bf16_f32 v78, v48, v49
    v_cvt_pk_bf16_f32 v79, v50, v51
    v_cvt_pk_bf16_f32 v80, v52, v53
    v_cvt_pk_bf16_f32 v81, v54, v55
    v_cvt_pk_bf16_f32 v82, v56, v57
    v_cvt_pk_bf16_f32 v83, v58, v59
    ds_write_b128 v118, v[76:79] offset:34816
    ds_write_b128 v118, v[80:83] offset:35840
    s_nop 0
    v_max3_f32 v116, |v60|, |v61|, |v62|
    v_max3_f32 v117, |v63|, |v64|, |v65|
    v_max3_f32 v116, v116, |v66|, |v67|
    v_max3_f32 v117, v117, |v68|, |v69|
    v_max3_f32 v116, v116, |v70|, |v71|
    v_max3_f32 v117, v117, |v72|, |v73|
    v_max3_f32 v116, v116, |v74|, |v75|
    v_max_f32 v116, v116, v117
    v_cmp_lt_f32 vcc, s50, v116
    v_exp_f32 v92, -v60
    v_exp_f32 v93, -v61
    v_exp_f32 v94, -v62
    v_exp_f32 v95, -v63
    s_nop 0
    s_cbranch_vccnz L_SMK1
    v_exp_f32 v96, -v64
    v_exp_f32 v97, -v65
    v_exp_f32 v98, -v66
    v_exp_f32 v99, -v67
    v_exp_f32 v100, -v68
    v_exp_f32 v101, -v69
    v_exp_f32 v102, -v70
    v_exp_f32 v103, -v71
    v_exp_f32 v104, -v72
    v_exp_f32 v105, -v73
    v_exp_f32 v106, -v74
    v_exp_f32 v107, -v75
L_SMK1B:
    v_exp_f32 v60, v60
    v_exp_f32 v61, v61
    v_exp_f32 v62, v62
    v_add_f32 v110, v92, v94
    v_exp_f32 v63, v63
    v_add_f32 v111, v93, v95
    v_add_f32 v108, v60, v62
    v_exp_f32 v64, v64
    v_add_f32 v110, v110, v96
    v_add_f32 v109, v61, v63
    v_exp_f32 v65, v65
    v_add_f32 v111, v111, v97
    v_add_f32 v108, v108, v64
    v_exp_f32 v66, v66
    v_add_f32 v110, v110, v98
    v_add_f32 v109, v109, v65
    v_exp_f32 v67, v67
    v_add_f32 v111, v111, v99
    v_add_f32 v108, v108, v66
    v_exp_f32 v68, v68
    v_add_f32 v110, v110, v100
    v_add_f32 v109, v109, v67
    v_exp_f32 v69, v69
    v_add_f32 v111, v111, v101
    v_add_f32 v108, v108, v68
    v_exp_f32 v70, v70
    v_add_f32 v110, v110, v102
    v_add_f32 v109, v109, v69
    v_exp_f32 v71, v71
    v_add_f32 v111, v111, v103
    v_add_f32 v108, v108, v70
    v_exp_f32 v72, v72
    v_add_f32 v110, v110, v104
    v_add_f32 v109, v109, v71
    v_exp_f32 v73, v73
    v_add_f32 v111, v111, v105
    v_add_f32 v108, v108, v72
    v_exp_f32 v74, v74
    v_add_f32 v110, v110, v106
    v_add_f32 v109, v109, v73
    v_exp_f32 v75, v75
    v_add_f32 v111, v111, v107
    v_add_f32 v108, v108, v74
    v_add_f32 v109, v109, v75
    v_add_f32 v117, v110, v111
    v_add_f32 v116, v108, v109
    v_rcp_f32 v117, v117
    v_rcp_f32 v116, v116
    v_mul_f32 v92, v92, v117
    v_mul_f32 v93, v93, v117
    v_mul_f32 v60, v60, v116
    v_mul_f32 v61, v61, v116
    v_mul_f32 v62, v62, v116
    v_mul_f32 v63, v63, v116
    v_cvt_pk_bf16_f32 v60, v60, v61
    v_mul_f32 v64, v64, v116
    v_mul_f32 v65, v65, v116
    v_cvt_pk_bf16_f32 v61, v62, v63
    v_mul_f32 v66, v66, v116
    v_mul_f32 v67, v67, v116
    v_cvt_pk_bf16_f32 v62, v64, v65
    v_mul_f32 v68, v68, v116
    v_mul_f32 v69, v69, v116
    v_cvt_pk_bf16_f32 v63, v66, v67
    v_mul_f32 v70, v70, v116
    v_mul_f32 v71, v71, v116
    v_cvt_pk_bf16_f32 v64, v68, v69
    v_mul_f32 v72, v72, v116
    v_mul_f32 v73, v73, v116
    v_cvt_pk_bf16_f32 v65, v70, v71
    v_mul_f32 v74, v74, v116
    v_mul_f32 v75, v75, v116
    v_cvt_pk_bf16_f32 v66, v72, v73
    v_cvt_pk_bf16_f32 v67, v74, v75
    v_mul_f32 v94, v94, v117
    v_mul_f32 v95, v95, v117
    v_cvt_pk_bf16_f32 v68, v92, v93
    v_mul_f32 v96, v96, v117
    v_mul_f32 v97, v97, v117
    v_cvt_pk_bf16_f32 v69, v94, v95
    v_mul_f32 v98, v98, v117
    v_mul_f32 v99, v99, v117
    v_cvt_pk_bf16_f32 v70, v96, v97
    v_mul_f32 v100, v100, v117
    v_mul_f32 v101, v101, v117
    v_cvt_pk_bf16_f32 v71, v98, v99
    v_mul_f32 v102, v102, v117
    v_mul_f32 v103, v103, v117
    v_cvt_pk_bf16_f32 v72, v100, v101
    v_mul_f32 v104, v104, v117
    v_mul_f32 v105, v105, v117
    v_cvt_pk_bf16_f32 v73, v102, v103
    v_mul_f32 v106, v106, v117
    v_mul_f32 v107, v107, v117
    v_cvt_pk_bf16_f32 v74, v104, v105
    v_cvt_pk_bf16_f32 v75, v106, v107
    ds_write_b128 v119, v[60:63] offset:16384
    v_xor_b32 v5, 16, v119
    ds_write_b128 v5, v[64:67] offset:16384
    v_xor_b32 v6, 32, v119
    ds_write_b128 v6, v[68:71] offset:16384
    v_xor_b32 v7, 48, v119
    ds_write_b128 v7, v[72:75] offset:16384
    v_mov_b32 v112, 0x3f803f80
    v_mov_b32 v113, 0x3f803f80
    v_mov_b32 v114, 0x3f803f80
    v_mov_b32 v115, 0x3f803f80
    v_xor_b32 v4, 32, v120
    v_lshlrev_b32 v16, 3, v2
    s_cmp_eq_u32 s39, 4
    s_cselect_b32 s34, 256, 0
    s_cselect_b32 s5, 4, 0
    buffer_load_dword v122, v123, s[32:35], 0 offen sc1
    s_waitcnt lgkmcnt(0)
    s_barrier
    s_setprio 2
    ds_read_b128 v[76:79], v121 offset:32768
    ds_read_b64_tr_b16 v[44:45], v120 offset:0
    ds_read_b64_tr_b16 v[46:47], v120 offset:512
    ds_read_b64_tr_b16 v[48:49], v4 offset:0
    ds_read_b64_tr_b16 v[50:51], v4 offset:512
    ds_read_b128 v[80:83], v121 offset:36864
    ds_read_b64_tr_b16 v[52:53], v120 offset:4096
    ds_read_b64_tr_b16 v[54:55], v120 offset:4608
    ds_read_b64_tr_b16 v[56:57], v4 offset:4096
    ds_read_b64_tr_b16 v[58:59], v4 offset:4608
    ds_read_b128 v[84:87], v121 offset:40960
    ds_read_b64_tr_b16 v[60:61], v120 offset:8192
    ds_read_b64_tr_b16 v[62:63], v120 offset:8704
    ds_read_b64_tr_b16 v[64:65], v4 offset:8192
    ds_read_b64_tr_b16 v[66:67], v4 offset:8704
    s_waitcnt lgkmcnt(12)
    v_mfma_f32_16x16x32_bf16 v[92:95], v[44:47], v[76:79], 0
    s_waitcnt lgkmcnt(10)
    v_mfma_f32_16x16x32_bf16 v[96:99], v[48:51], v[76:79], 0
    ds_read_b128 v[88:91], v121 offset:45056
    ds_read_b64_tr_b16 v[68:69], v120 offset:12288
    ds_read_b64_tr_b16 v[70:71], v120 offset:12800
    ds_read_b64_tr_b16 v[72:73], v4 offset:12288
    ds_read_b64_tr_b16 v[74:75], v4 offset:12800
    v_mfma_f32_16x16x32_bf16 v[100:103], v[112:115], v[44:47], 0
    v_mfma_f32_16x16x32_bf16 v[104:107], v[112:115], v[48:51], 0
    s_waitcnt lgkmcnt(12)
    v_mfma_f32_16x16x32_bf16 v[92:95], v[52:55], v[80:83], v[92:95]
    s_waitcnt lgkmcnt(10)
    v_mfma_f32_16x16x32_bf16 v[96:99], v[56:59], v[80:83], v[96:99]
    v_mfma_f32_16x16x32_bf16 v[100:103], v[112:115], v[52:55], v[100:103]
    v_mfma_f32_16x16x32_bf16 v[104:107], v[112:115], v[56:59], v[104:107]
    s_waitcnt lgkmcnt(7)
    v_mfma_f32_16x16x32_bf16 v[92:95], v[60:63], v[84:87], v[92:95]
    s_waitcnt lgkmcnt(5)
    v_mfma_f32_16x16x32_bf16 v[96:99], v[64:67], v[84:87], v[96:99]
    s_waitcnt lgkmcnt(2)
    v_mfma_f32_16x16x32_bf16 v[92:95], v[68:71], v[88:91], v[92:95]
    s_waitcnt lgkmcnt(0)
    v_mfma_f32_16x16x32_bf16 v[96:99], v[72:75], v[88:91], v[96:99]
    v_mfma_f32_16x16x32_bf16 v[100:103], v[112:115], v[60:63], v[100:103]
    v_mfma_f32_16x16x32_bf16 v[104:107], v[112:115], v[64:67], v[104:107]
    v_mfma_f32_16x16x32_bf16 v[100:103], v[112:115], v[68:71], v[100:103]
    v_mfma_f32_16x16x32_bf16 v[104:107], v[112:115], v[72:75], v[104:107]
    s_nop 1
    v_cvt_pk_bf16_f32 v108, v92, v93
    v_cvt_pk_bf16_f32 v109, v94, v95
    v_cvt_pk_bf16_f32 v110, v96, v97
    v_cvt_pk_bf16_f32 v111, v98, v99
    v_min_u32 v124, -2, v108
    v_min_u32 v125, -2, v109
    v_min_u32 v126, -2, v110
    v_min_u32 v127, -2, v111
    buffer_store_dwordx4 v[124:127], v26, s[28:31], s52 offen sc1
    v_min_u32 v6, -2, v100
    v_min_u32 v7, -2, v104
    s_mov_b64 exec, 0xffff
    buffer_store_dwordx2 v[6:7], v16, s[28:31], s53 offen sc1
    s_mov_b64 exec, -1
    v_lshrrev_b32 v12, 3, v2
    v_lshl_add_u32 v12, v12, 10, v27
    s_lshl_b32 s42, s40, 14
    s_lshl_b32 s43, s73, 8
    s_add_u32 s42, s42, s43
    v_add_u32 v12, s42, v12
    v_add_u32 v13, 7168, v12
    v_add_u32 v14, 128, v12
    v_add_u32 v15, 128, v13
    s_lshl_b32 s43, s57, 16
    s_add_u32 m0, s48, 73728
    s_nop 0
    buffer_load_dwordx4 v12, s[20:23], s43 offen lds
    buffer_load_dwordx4 v13, s[20:23], s43 offen offset:1024 lds
    s_add_u32 m0, s48, 81920
    s_nop 0
    buffer_load_dwordx4 v14, s[20:23], s43 offen lds
    buffer_load_dwordx4 v15, s[20:23], s43 offen offset:1024 lds
    v_bfe_u32 v20, v2, 2, 2
    v_lshl_add_u32 v20, v3, 4, v20
    v_lshlrev_b32 v20, 7, v20
    v_bfe_u32 v21, v2, 3, 1
    s_and_b32 s44, s40, 1
    v_xor_b32 v21, s44, v21
    v_lshl_add_u32 v20, v21, 6, v20
    v_and_b32 v21, 1, v2
    v_lshl_add_u32 v20, v21, 5, v20
    v_bfe_u32 v21, v2, 4, 1
    v_lshl_add_u32 v20, v21, 4, v20
    v_bfe_u32 v21, v2, 1, 1
    v_lshl_add_u32 v20, v21, 3, v20
    s_lshr_b32 s44, s40, 1
    s_lshl_b32 s44, s44, 13
    v_add_u32 v20, s44, v20
    v_add_u32 v21, 0x10000, v20
    v_add_u32 v22, 0x20000, v20
    v_and_b32 v119, 15, v2
    v_lshlrev_b32 v120, 1, v119
    v_mul_u32_u24 v119, 80, v119
    v_lshrrev_b32 v121, 4, v2
    v_lshl_add_u32 v119, v121, 3, v119
    s_mul_i32 s44, s40, 1280
    v_add_u32 v119, s44, v119
    s_lshl_b32 s44, s40, 6
    v_add_u32 v120, s44, v120
    v_lshl_add_u32 v120, v3, 5, v120
    v_and_b32 v8, 31, v2
    v_lshlrev_b32 v9, 2, v3
    v_sub_u32 v8, v8, v9
    v_mov_b32 v10, 0x3f80
    v_mov_b32 v11, 0x3f800000
    v_cmp_eq_u32 vcc, 0, v8
    s_nop 1
    v_cndmask_b32 v36, 0, v10, vcc
    v_cmp_eq_u32 vcc, 1, v8
    s_nop 1
    v_cndmask_b32 v36, v36, v11, vcc
    v_cmp_eq_u32 vcc, 2, v8
    s_nop 1
    v_cndmask_b32 v37, 0, v10, vcc
    v_cmp_eq_u32 vcc, 3, v8
    s_nop 1
    v_cndmask_b32 v37, v37, v11, vcc
    v_cmp_eq_u32 vcc, 8, v8
    s_nop 1
    v_cndmask_b32 v38, 0, v10, vcc
    v_cmp_eq_u32 vcc, 9, v8
    s_nop 1
    v_cndmask_b32 v38, v38, v11, vcc
    v_cmp_eq_u32 vcc, 10, v8
    s_nop 1
    v_cndmask_b32 v39, 0, v10, vcc
    v_cmp_eq_u32 vcc, 11, v8
    s_nop 1
    v_cndmask_b32 v39, v39, v11, vcc
    s_nop 1
    v_mfma_f32_32x32x16_bf16 a[112:127], v[36:39], v[124:127], 0
    s_mov_b32 s55, 0x8000
    s_waitcnt vmcnt(6)
    s_nop 9
L_INIT1:
    v_bfe_u32 v122, v122, 0, 8
    v_cmp_gt_u32 vcc, s5, v122
    s_nop 4
    s_cbranch_vccz L_INIT1OK
    s_sub_u32 s55, s55, 1
    s_cbranch_scc1 L_INIT1OK
    s_sleep 4
    buffer_load_dword v122, v123, s[32:35], 0 offen sc1
    s_waitcnt vmcnt(0)
    s_branch L_INIT1
L_INIT1OK:
    s_barrier
    s_lshl_b32 s43, s58, 16
    s_add_u32 m0, s48, 0
    s_nop 0
    buffer_load_dwordx4 v12, s[20:23], s43 offen lds
    buffer_load_dwordx4 v13, s[20:23], s43 offen offset:1024 lds
    s_add_u32 m0, s48, 8192
    s_nop 0
    buffer_load_dwordx4 v14, s[20:23], s43 offen lds
    buffer_load_dwordx4 v15, s[20:23], s43 offen offset:1024 lds
    s_setprio 2
    s_add_u32 s42, s37, 4
    s_and_b32 s42, s42, 15
    s_lshl_b32 s42, s42, 10
    s_add_u32 s42, s42, s76
    buffer_load_dwordx4 v[44:47], v26, s[28:31], s42 offen sc1
    s_add_u32 s42, s37, 8
    s_and_b32 s42, s42, 15
    s_lshl_b32 s42, s42, 10
    s_add_u32 s42, s42, s76
    buffer_load_dwordx4 v[48:51], v26, s[28:31], s42 offen sc1
    s_add_u32 s42, s37, 12
    s_and_b32 s42, s42, 15
    s_lshl_b32 s42, s42, 10
    s_add_u32 s42, s42, s76
    buffer_load_dwordx4 v[52:55], v26, s[28:31], s42 offen sc1
    s_add_u32 s42, s37, 5
    s_and_b32 s42, s42, 15
    s_lshl_b32 s42, s42, 10
    s_add_u32 s42, s42, s76
    buffer_load_dwordx4 v[56:59], v26, s[28:31], s42 offen sc1
    s_add_u32 s42, s37, 9
    s_and_b32 s42, s42, 15
    s_lshl_b32 s42, s42, 10
    s_add_u32 s42, s42, s76
    buffer_load_dwordx4 v[60:63], v26, s[28:31], s42 offen sc1
    s_add_u32 s42, s37, 13
    s_and_b32 s42, s42, 15
    s_lshl_b32 s42, s42, 10
    s_add_u32 s42, s42, s76
    buffer_load_dwordx4 v[64:67], v26, s[28:31], s42 offen sc1
    s_add_u32 s42, s37, 6
    s_and_b32 s42, s42, 15
    s_lshl_b32 s42, s42, 10
    s_add_u32 s42, s42, s76
    buffer_load_dwordx4 v[68:71], v26, s[28:31], s42 offen sc1
    s_add_u32 s42, s37, 10
    s_and_b32 s42, s42, 15
    s_lshl_b32 s42, s42, 10
    s_add_u32 s42, s42, s76
    buffer_load_dwordx4 v[72:75], v26, s[28:31], s42 offen sc1
    s_add_u32 s42, s37, 14
    s_and_b32 s42, s42, 15
    s_lshl_b32 s42, s42, 10
    s_add_u32 s42, s42, s76
    buffer_load_dwordx4 v[76:79], v26, s[28:31], s42 offen sc1
    s_add_u32 s42, s37, 7
    s_and_b32 s42, s42, 15
    s_lshl_b32 s42, s42, 10
    s_add_u32 s42, s42, s76
    buffer_load_dwordx4 v[80:83], v26, s[28:31], s42 offen sc1
    s_add_u32 s42, s37, 11
    s_and_b32 s42, s42, 15
    s_lshl_b32 s42, s42, 10
    s_add_u32 s42, s42, s76
    buffer_load_dwordx4 v[84:87], v26, s[28:31], s42 offen sc1
    s_add_u32 s42, s37, 15
    s_and_b32 s42, s42, 15
    s_lshl_b32 s42, s42, 10
    s_add_u32 s42, s42, s76
    buffer_load_dwordx4 v[88:91], v26, s[28:31], s42 offen sc1
    s_add_u32 s42, s37, 1
    s_and_b32 s42, s42, 15
    s_lshl_b32 s42, s42, 10
    s_add_u32 s42, s42, s76
    buffer_load_dwordx4 v[92:95], v26, s[28:31], s42 offen sc1
    s_add_u32 s42, s37, 2
    s_and_b32 s42, s42, 15
    s_lshl_b32 s42, s42, 10
    s_add_u32 s42, s42, s76
    buffer_load_dwordx4 v[96:99], v26, s[28:31], s42 offen sc1
    s_add_u32 s42, s37, 3
    s_and_b32 s42, s42, 15
    s_lshl_b32 s42, s42, 10
    s_add_u32 s42, s42, s76
    buffer_load_dwordx4 v[100:103], v26, s[28:31], s42 offen sc1
    buffer_load_dwordx2 v[108:109], v16, s[28:31], s77 offen offset:0 sc1
    buffer_load_dwordx2 v[110:111], v16, s[28:31], s77 offen offset:512 sc1
    buffer_load_dwordx2 v[112:113], v16, s[28:31], s77 offen offset:1024 sc1
    buffer_load_dwordx2 v[114:115], v16, s[28:31], s77 offen offset:1536 sc1
    s_mov_b32 s45, 0
    s_waitcnt vmcnt(18)
    v_cmp_eq_u32 s[64:65], -1, v44
    s_waitcnt vmcnt(17)
    v_cmp_eq_u32 s[66:67], -1, v48
    s_cmp_lg_u64 s[64:65], 0
    s_cbranch_scc1 L_GB0
    v_mfma_f32_32x32x16_bf16 a[112:127], v[36:39], v[44:47], a[112:127]
L_GB0R:
    s_waitcnt vmcnt(16)
    v_cmp_eq_u32 s[64:65], -1, v52
    s_cmp_lg_u64 s[66:67], 0
    s_cbranch_scc1 L_GB1
    v_mfma_f32_32x32x16_bf16 a[112:127], v[36:39], v[48:51], a[112:127]
L_GB1R:
    s_waitcnt vmcnt(15)
    v_cmp_eq_u32 s[66:67], -1, v56
    s_cmp_lg_u64 s[64:65], 0
    s_cbranch_scc1 L_GB2
    v_mfma_f32_32x32x16_bf16 a[112:127], v[36:39], v[52:55], a[112:127]
L_GB2R:
    s_waitcnt vmcnt(14)
    v_cmp_eq_u32 s[64:65], -1, v60
    s_cmp_lg_u64 s[66:67], 0
    s_cbranch_scc1 L_GB3
    v_mfma_f32_32x32x16_bf16 a[112:127], v[36:39], v[56:59], a[112:127]
L_GB3R:
    s_waitcnt vmcnt(13)
    v_cmp_eq_u32 s[66:67], -1, v64
    s_cmp_lg_u64 s[64:65], 0
    s_cbranch_scc1 L_GB4
    v_mfma_f32_32x32x16_bf16 a[112:127], v[36:39], v[60:63], a[112:127]
L_GB4R:
    s_waitcnt vmcnt(12)
    v_cmp_eq_u32 s[64:65], -1, v68
    s_cmp_lg_u64 s[66:67], 0
    s_cbranch_scc1 L_GB5
    v_mfma_f32_32x32x16_bf16 a[112:127], v[36:39], v[64:67], a[112:127]
L_GB5R:
    s_waitcnt vmcnt(11)
    v_cmp_eq_u32 s[66:67], -1, v72
    s_cmp_lg_u64 s[64:65], 0
    s_cbranch_scc1 L_GB6
    v_mfma_f32_32x32x16_bf16 a[112:127], v[36:39], v[68:71], a[112:127]
L_GB6R:
    s_waitcnt vmcnt(10)
    v_cmp_eq_u32 s[64:65], -1, v76
    s_cmp_lg_u64 s[66:67], 0
    s_cbranch_scc1 L_GB7
    v_mfma_f32_32x32x16_bf16 a[112:127], v[36:39], v[72:75], a[112:127]
L_GB7R:
    s_waitcnt vmcnt(9)
    v_cmp_eq_u32 s[66:67], -1, v80
    s_cmp_lg_u64 s[64:65], 0
    s_cbranch_scc1 L_GB8
    v_mfma_f32_32x32x16_bf16 a[112:127], v[36:39], v[76:79], a[112:127]
L_GB8R:
    s_waitcnt vmcnt(8)
    v_cmp_eq_u32 s[64:65], -1, v84
    s_cmp_lg_u64 s[66:67], 0
    s_cbranch_scc1 L_GB9
    v_mfma_f32_32x32x16_bf16 a[112:127], v[36:39], v[80:83], a[112:127]
L_GB9R:
    s_waitcnt vmcnt(7)
    v_cmp_eq_u32 s[66:67], -1, v88
    s_cmp_lg_u64 s[64:65], 0
    s_cbranch_scc1 L_GB10
    v_mfma_f32_32x32x16_bf16 a[112:127], v[36:39], v[84:87], a[112:127]
L_GB10R:
    s_lshl_b32 s43, s59, 16
    s_add_u32 m0, s48, 16384
    s_nop 0
    buffer_load_dwordx4 v12, s[20:23], s43 offen lds
    buffer_load_dwordx4 v13, s[20:23], s43 offen offset:1024 lds
    s_add_u32 m0, s48, 24576
    s_nop 0
    buffer_load_dwordx4 v14, s[20:23], s43 offen lds
    buffer_load_dwordx4 v15, s[20:23], s43 offen offset:1024 lds
    s_waitcnt vmcnt(10)
    v_cmp_eq_u32 s[64:65], -1, v92
    s_cmp_lg_u64 s[66:67], 0
    s_cbranch_scc1 L_GB11
    v_mfma_f32_32x32x16_bf16 a[112:127], v[36:39], v[88:91], a[112:127]
L_GB11R:
    s_lshl_b32 s43, s60, 16
    s_add_u32 m0, s48, 32768
    s_nop 0
    buffer_load_dwordx4 v12, s[20:23], s43 offen lds
    buffer_load_dwordx4 v13, s[20:23], s43 offen offset:1024 lds
    s_add_u32 m0, s48, 40960
    s_nop 0
    buffer_load_dwordx4 v14, s[20:23], s43 offen lds
    buffer_load_dwordx4 v15, s[20:23], s43 offen offset:1024 lds
    s_waitcnt vmcnt(13)
    v_cmp_eq_u32 s[66:67], -1, v96
    s_cmp_lg_u64 s[64:65], 0
    s_cbranch_scc1 L_GB12
    v_mfma_f32_32x32x16_bf16 a[112:127], v[36:39], v[92:95], a[112:127]
L_GB12R:
    s_waitcnt vmcnt(12)
    v_cmp_eq_u32 s[64:65], -1, v100
    s_cmp_lg_u64 s[66:67], 0
    s_cbranch_scc1 L_GB13
    v_mfma_f32_32x32x16_bf16 a[112:127], v[36:39], v[96:99], a[112:127]
L_GB13R:
    s_cmp_lg_u64 s[64:65], 0
    s_cbranch_scc1 L_GB14
    v_mfma_f32_32x32x16_bf16 a[112:127], v[36:39], v[100:103], a[112:127]
L_GB14R:
    s_nop 11
L_ZSUM:
    s_waitcnt vmcnt(10)
    v_add_f32 v28, v108, v110
    s_waitcnt vmcnt(8)
    v_add_f32 v30, v112, v114
    v_add_f32 v29, v109, v111
    v_add_f32 v31, v113, v115
    v_add_f32 v28, v28, v30
    v_add_f32 v29, v29, v31
    s_nop 1
    v_permlane32_swap_b32 v28, v29
    v_add_f32 v28, v28, v29
    v_mov_b32 v29, v28
    s_nop 1
    v_permlane16_swap_b32 v28, v29
    v_add_f32 v28, v28, v29
    v_cvt_pk_bf16_f32 v30, v28, v28
    s_cmp_lg_u32 s45, 0
    s_cbranch_scc1 L_GPEND
    v_accvgpr_read_b32 v4, a112
    v_accvgpr_read_b32 v5, a113
    v_accvgpr_read_b32 v6, a114
    v_accvgpr_read_b32 v7, a115
    v_accvgpr_read_b32 v8, a116
    v_accvgpr_read_b32 v9, a117
    v_accvgpr_read_b32 v10, a118
    v_accvgpr_read_b32 v11, a119
    v_cmp_u_f32 vcc, v4, v28
    v_cvt_pk_bf16_f32 v32, v4, v5
    v_cvt_pk_bf16_f32 v33, v6, v7
    v_cvt_pk_bf16_f32 v34, v8, v9
    v_cvt_pk_bf16_f32 v35, v10, v11
    s_bitcmp1_b32 s54, 0
    s_cbranch_scc1 L_SUMOK
    s_cbranch_vccnz L_GSLOW
L_SUMOK:
    ds_write_b64 v119, v[32:33] offset:49152
    ds_write_b64 v119, v[34:35] offset:49184
    ds_write_b16 v120, v30 offset:54272
    s_waitcnt lgkmcnt(0)
    s_barrier
    s_setprio 0
    s_lshl_b32 s43, s61, 16
    s_add_u32 m0, s48, 131072
    s_nop 0
    buffer_load_dwordx4 v12, s[20:23], s43 offen lds
    buffer_load_dwordx4 v13, s[20:23], s43 offen offset:1024 lds
    s_add_u32 m0, s48, 139264
    s_nop 0
    buffer_load_dwordx4 v14, s[20:23], s43 offen lds
    buffer_load_dwordx4 v15, s[20:23], s43 offen offset:1024 lds
    s_lshl_b32 s43, s62, 16
    s_add_u32 m0, s48, 147456
    s_nop 0
    buffer_load_dwordx4 v12, s[20:23], s43 offen lds
    buffer_load_dwordx4 v13, s[20:23], s43 offen offset:1024 lds
    s_add_u32 m0, s48, 155648
    s_nop 0
    buffer_load_dwordx4 v14, s[20:23], s43 offen lds
    buffer_load_dwordx4 v15, s[20:23], s43 offen offset:1024 lds
    ds_read_b64_tr_b16 a[0:1], v20 offset:57344
    ds_read_b64_tr_b16 a[2:3], v20 offset:57856
    ds_read_b64_tr_b16 a[4:5], v20 offset:58368
    ds_read_b64_tr_b16 a[6:7], v20 offset:58880
    ds_read_b64_tr_b16 a[8:9], v20 offset:61440
    ds_read_b64_tr_b16 a[10:11], v20 offset:61952
    ds_read_b64_tr_b16 a[12:13], v20 offset:62464
    ds_read_b64_tr_b16 a[14:15], v20 offset:62976
    ds_read_b64_tr_b16 a[16:17], v21 offset:8192
    ds_read_b64_tr_b16 a[18:19], v21 offset:8704
    ds_read_b64_tr_b16 a[20:21], v21 offset:9216
    ds_read_b64_tr_b16 a[22:23], v21 offset:9728
    ds_read_b64_tr_b16 a[24:25], v21 offset:12288
    ds_read_b64_tr_b16 a[26:27], v21 offset:12800
    ds_read_b64_tr_b16 a[28:29], v21 offset:13312
    ds_read_b64_tr_b16 a[30:31], v21 offset:13824
    ds_read_b64_tr_b16 a[32:33], v20 offset:0
    ds_read_b64_tr_b16 a[34:35], v20 offset:512
    ds_read_b64_tr_b16 a[36:37], v20 offset:1024
    ds_read_b64_tr_b16 a[38:39], v20 offset:1536
    ds_read_b64_tr_b16 a[40:41], v20 offset:4096
    ds_read_b64_tr_b16 a[42:43], v20 offset:4608
    ds_read_b64_tr_b16 a[44:45], v20 offset:5120
    ds_read_b64_tr_b16 a[46:47], v20 offset:5632
    s_waitcnt lgkmcnt(0)
    s_lshl_b32 s64, s56, 12
    s_add_u32 s64, s64, s75
    s_lshl_b32 s65, s57, 12
    s_add_u32 s65, s65, s75
    s_lshl_b32 s66, s58, 12
    s_add_u32 s66, s66, s75
    s_lshl_b32 s67, s59, 12
    s_add_u32 s67, s67, s75
    s_lshl_b32 s68, s60, 12
    s_add_u32 s68, s68, s75
    s_lshl_b32 s69, s61, 12
    s_add_u32 s69, s69, s75
    s_lshl_b32 s70, s62, 12
    s_add_u32 s70, s70, s75
    s_lshl_b32 s71, s63, 12
    s_add_u32 s71, s71, s75
    v_add_u32 v16, 98304, v26
    v_and_b32 v17, 31, v2
    v_lshlrev_b32 v17, 11, v17
    v_lshl_add_u32 v17, v3, 5, v17
    s_lshl_b32 s42, s72, 17
    s_lshl_b32 s43, s36, 10
    s_add_u32 s42, s42, s43
    s_lshl_b32 s43, s73, 8
    s_add_u32 s42, s42, s43
    s_lshl_b32 s43, s40, 6
    s_add_u32 s42, s42, s43
    s_add_u32 s43, s42, 0x10000
    v_mov_b32 v44, 0
    v_mov_b32 v45, 0
    v_mov_b32 v46, 0
    v_mov_b32 v47, 0
    v_mov_b32 v48, 0
    v_mov_b32 v49, 0
    v_mov_b32 v50, 0
    v_mov_b32 v51, 0
    v_mov_b32 v52, 0
    v_mov_b32 v53, 0
    v_mov_b32 v54, 0
    v_mov_b32 v55, 0
    v_mov_b32 v56, 0
    v_mov_b32 v57, 0
    v_mov_b32 v58, 0
    v_mov_b32 v59, 0
    v_mov_b32 v60, 0
    v_mov_b32 v61, 0
    v_mov_b32 v62, 0
    v_mov_b32 v63, 0
    v_mov_b32 v64, 0
    v_mov_b32 v65, 0
    v_mov_b32 v66, 0
    v_mov_b32 v67, 0
    v_mov_b32 v68, 0
    v_mov_b32 v69, 0
    v_mov_b32 v70, 0
    v_mov_b32 v71, 0
    v_mov_b32 v72, 0
    v_mov_b32 v73, 0
    v_mov_b32 v74, 0
    v_mov_b32 v75, 0
    s_waitcnt vmcnt(0)
    s_barrier
    s_setprio 2
    s_lshl_b32 s43, s63, 16
    s_add_u32 m0, s48, 57344
    s_nop 0
    buffer_load_dwordx4 v12, s[20:23], s43 offen lds
    buffer_load_dwordx4 v13, s[20:23], s43 offen offset:1024 lds
    s_add_u32 m0, s48, 65536
    s_nop 0
    buffer_load_dwordx4 v14, s[20:23], s43 offen lds
    buffer_load_dwordx4 v15, s[20:23], s43 offen offset:1024 lds
    s_add_u32 s43, s42, 0x10000
    v_lshrrev_b32 v18, 4, v2
    v_and_b32 v19, 15, v2
    v_lshlrev_b32 v19, 4, v19
    v_mul_u32_u24 v7, 272, v18
    v_add_u32 v7, v7, v19
    v_lshl_add_u32 v19, v18, 11, v19
    s_mul_i32 s42, s39, 2176
    v_add_u32 v18, s42, v7
    s_lshl_b32 s42, s72, 17
    s_lshl_b32 s43, s36, 10
    s_add_u32 s42, s42, s43
    s_lshl_b32 s43, s73, 8
    s_add_u32 s42, s42, s43
    s_lshl_b32 s43, s39, 14
    s_add_u32 s42, s42, s43
    s_add_u32 s43, s42, 0x2000
    v_and_b32 v17, 31, v2
    v_mul_u32_u24 v17, 272, v17
    v_lshl_add_u32 v17, v3, 5, v17
    s_lshl_b32 s44, s40, 6
    v_add_u32 v17, s44, v17
    ds_read_b64_tr_b16 a[48:49], v20 offset:16384
    ds_read_b64_tr_b16 a[50:51], v20 offset:16896
    ds_read_b64_tr_b16 a[52:53], v20 offset:17408
    ds_read_b64_tr_b16 a[54:55], v20 offset:17920
    ds_read_b64_tr_b16 a[56:57], v20 offset:20480
    ds_read_b64_tr_b16 a[58:59], v20 offset:20992
    ds_read_b64_tr_b16 a[60:61], v20 offset:21504
    ds_read_b64_tr_b16 a[62:63], v20 offset:22016
    ds_read_b64_tr_b16 a[64:65], v20 offset:32768
    ds_read_b64_tr_b16 a[66:67], v20 offset:33280
    ds_read_b64_tr_b16 a[68:69], v20 offset:33792
    ds_read_b64_tr_b16 a[70:71], v20 offset:34304
    ds_read_b64_tr_b16 a[72:73], v20 offset:36864
    ds_read_b64_tr_b16 a[74:75], v20 offset:37376
    ds_read_b64_tr_b16 a[76:77], v20 offset:37888
    ds_read_b64_tr_b16 a[78:79], v20 offset:38400
    ds_read_b64_tr_b16 a[80:81], v22 offset:0
    ds_read_b64_tr_b16 a[82:83], v22 offset:512
    ds_read_b64_tr_b16 a[84:85], v22 offset:1024
    ds_read_b64_tr_b16 a[86:87], v22 offset:1536
    ds_read_b64_tr_b16 a[88:89], v22 offset:4096
    ds_read_b64_tr_b16 a[90:91], v22 offset:4608
    ds_read_b64_tr_b16 a[92:93], v22 offset:5120
    ds_read_b64_tr_b16 a[94:95], v22 offset:5632
    ds_read_b64_tr_b16 a[96:97], v22 offset:16384
    ds_read_b64_tr_b16 a[98:99], v22 offset:16896
    ds_read_b64_tr_b16 a[100:101], v22 offset:17408
    ds_read_b64_tr_b16 a[102:103], v22 offset:17920
    ds_read_b64_tr_b16 a[104:105], v22 offset:20480
    ds_read_b64_tr_b16 a[106:107], v22 offset:20992
    ds_read_b64_tr_b16 a[108:109], v22 offset:21504
    ds_read_b64_tr_b16 a[110:111], v22 offset:22016
    s_waitcnt lgkmcnt(0)
    s_barrier
    ds_read_b128 v[76:79], v16 offset:0
    ds_read_b128 v[80:83], v16 offset:1024
    ds_read_b128 v[84:87], v16 offset:2048
    ds_read_b128 v[88:91], v16 offset:3072
    ds_read_b128 v[92:95], v16 offset:4096
    ds_read_b128 v[96:99], v16 offset:5120
    ds_read_b128 v[100:103], v16 offset:6144
    ds_read_b128 v[104:107], v16 offset:7168
    s_waitcnt lgkmcnt(7)
    v_mfma_f32_32x32x16_bf16 v[44:59], a[0:3], v[76:79], v[44:59]
    s_waitcnt lgkmcnt(6)
    v_mfma_f32_32x32x16_bf16 v[44:59], a[4:7], v[80:83], v[44:59]
    ds_read_b128 v[108:111], v16 offset:8192
    ds_read_b128 v[112:115], v16 offset:9216
    s_waitcnt lgkmcnt(7)
    v_mfma_f32_32x32x16_bf16 v[44:59], a[16:19], v[84:87], v[44:59]
    ds_read_b128 v[116:119], v16 offset:10240
    ds_read_b128 v[120:123], v16 offset:11264
    s_waitcnt lgkmcnt(8)
    v_mfma_f32_32x32x16_bf16 v[44:59], a[20:23], v[88:91], v[44:59]
    s_waitcnt lgkmcnt(7)
    v_mfma_f32_32x32x16_bf16 v[60:75], a[0:3], v[92:95], v[60:75]
    s_waitcnt lgkmcnt(6)
    v_mfma_f32_32x32x16_bf16 v[60:75], a[4:7], v[96:99], v[60:75]
    ds_read_b128 v[76:79], v16 offset:12288
    ds_read_b128 v[80:83], v16 offset:13312
    s_waitcnt lgkmcnt(7)
    v_mfma_f32_32x32x16_bf16 v[60:75], a[16:19], v[100:103], v[60:75]
    ds_read_b128 v[84:87], v16 offset:14336
    ds_read_b128 v[88:91], v16 offset:15360
    s_waitcnt lgkmcnt(8)
    v_mfma_f32_32x32x16_bf16 v[60:75], a[20:23], v[104:107], v[60:75]
    s_waitcnt lgkmcnt(7)
    v_mfma_f32_32x32x16_bf16 v[44:59], a[32:35], v[108:111], v[44:59]
    s_waitcnt lgkmcnt(6)
    v_mfma_f32_32x32x16_bf16 v[44:59], a[36:39], v[112:115], v[44:59]
    s_waitcnt vmcnt(0)
    s_barrier
    ds_read_b128 v[92:95], v16 offset:16384
    ds_read_b128 v[96:99], v16 offset:17408
    s_waitcnt lgkmcnt(7)
    v_mfma_f32_32x32x16_bf16 v[44:59], a[48:51], v[116:119], v[44:59]
    ds_read_b128 v[100:103], v16 offset:18432
    ds_read_b128 v[104:107], v16 offset:19456
    s_waitcnt lgkmcnt(8)
    v_mfma_f32_32x32x16_bf16 v[44:59], a[52:55], v[120:123], v[44:59]
    s_waitcnt lgkmcnt(7)
    v_mfma_f32_32x32x16_bf16 v[60:75], a[32:35], v[76:79], v[60:75]
    ds_read_b64_tr_b16 a[112:113], v20 offset:57344
    ds_read_b64_tr_b16 a[114:115], v20 offset:57856
    ds_read_b64_tr_b16 a[116:117], v20 offset:58368
    ds_read_b64_tr_b16 a[118:119], v20 offset:58880
    s_waitcnt lgkmcnt(10)
    v_mfma_f32_32x32x16_bf16 v[60:75], a[36:39], v[80:83], v[60:75]
    ds_read_b128 v[108:111], v16 offset:20480
    ds_read_b128 v[112:115], v16 offset:21504
    s_waitcnt lgkmcnt(11)
    v_mfma_f32_32x32x16_bf16 v[60:75], a[48:51], v[84:87], v[60:75]
    ds_read_b128 v[116:119], v16 offset:22528
    ds_read_b128 v[120:123], v16 offset:23552
    s_waitcnt lgkmcnt(12)
    v_mfma_f32_32x32x16_bf16 v[60:75], a[52:55], v[88:91], v[60:75]
    s_waitcnt lgkmcnt(11)
    v_mfma_f32_32x32x16_bf16 v[44:59], a[64:67], v[92:95], v[44:59]
    ds_read_b64_tr_b16 a[120:121], v20 offset:61440
    ds_read_b64_tr_b16 a[122:123], v20 offset:61952
    ds_read_b64_tr_b16 a[124:125], v20 offset:62464
    ds_read_b64_tr_b16 a[126:127], v20 offset:62976
    s_waitcnt lgkmcnt(14)
    v_mfma_f32_32x32x16_bf16 v[44:59], a[68:71], v[96:99], v[44:59]
    ds_read_b128 v[76:79], v16 offset:24576
    s_waitcnt lgkmcnt(14)
    ds_read_b128 v[80:83], v16 offset:25600
    v_mfma_f32_32x32x16_bf16 v[44:59], a[80:83], v[100:103], v[44:59]
    s_waitcnt lgkmcnt(14)
    ds_read_b128 v[84:87], v16 offset:26624
    s_waitcnt lgkmcnt(14)
    ds_read_b128 v[88:91], v16 offset:27648
    v_mfma_f32_32x32x16_bf16 v[44:59], a[84:87], v[104:107], v[44:59]
    s_waitcnt lgkmcnt(11)
    v_mfma_f32_32x32x16_bf16 v[60:75], a[64:67], v[108:111], v[60:75]
    s_waitcnt lgkmcnt(10)
    v_mfma_f32_32x32x16_bf16 v[60:75], a[68:71], v[112:115], v[60:75]
    ds_read_b128 v[92:95], v16 offset:28672
    ds_read_b128 v[96:99], v16 offset:29696
    s_waitcnt lgkmcnt(11)
    v_mfma_f32_32x32x16_bf16 v[60:75], a[80:83], v[116:119], v[60:75]
    ds_read_b128 v[100:103], v16 offset:30720
    ds_read_b128 v[104:107], v16 offset:31744
    s_waitcnt lgkmcnt(12)
    v_mfma_f32_32x32x16_bf16 v[60:75], a[84:87], v[120:123], v[60:75]
    s_waitcnt lgkmcnt(7)
    v_mfma_f32_32x32x16_bf16 v[44:59], a[96:99], v[76:79], v[44:59]
    s_waitcnt lgkmcnt(6)
    v_mfma_f32_32x32x16_bf16 v[44:59], a[100:103], v[80:83], v[44:59]
    s_barrier
    ds_read_b128 v[108:111], v16 offset:32768
    ds_read_b128 v[112:115], v16 offset:33792
    s_waitcnt lgkmcnt(7)
    v_mfma_f32_32x32x16_bf16 v[44:59], a[112:115], v[84:87], v[44:59]
    ds_read_b128 v[116:119], v16 offset:34816
    ds_read_b128 v[120:123], v16 offset:35840
    s_waitcnt lgkmcnt(8)
    v_mfma_f32_32x32x16_bf16 v[44:59], a[116:119], v[88:91], v[44:59]
    s_waitcnt lgkmcnt(7)
    v_mfma_f32_32x32x16_bf16 v[60:75], a[96:99], v[92:95], v[60:75]
    s_waitcnt lgkmcnt(6)
    v_mfma_f32_32x32x16_bf16 v[60:75], a[100:103], v[96:99], v[60:75]
    ds_read_b128 v[76:79], v16 offset:36864
    ds_read_b128 v[80:83], v16 offset:37888
    s_waitcnt lgkmcnt(7)
    v_mfma_f32_32x32x16_bf16 v[60:75], a[112:115], v[100:103], v[60:75]
    ds_read_b128 v[84:87], v16 offset:38912
    ds_read_b128 v[88:91], v16 offset:39936
    s_waitcnt lgkmcnt(8)
    v_mfma_f32_32x32x16_bf16 v[60:75], a[116:119], v[104:107], v[60:75]
    s_waitcnt lgkmcnt(7)
    v_mfma_f32_32x32x16_bf16 v[44:59], a[8:11], v[108:111], v[44:59]
    s_waitcnt lgkmcnt(6)
    v_mfma_f32_32x32x16_bf16 v[44:59], a[12:15], v[112:115], v[44:59]
    s_barrier
    ds_read_b128 v[92:95], v16 offset:40960
    ds_read_b128 v[96:99], v16 offset:41984
    s_waitcnt lgkmcnt(7)
    v_mfma_f32_32x32x16_bf16 v[44:59], a[24:27], v[116:119], v[44:59]
    ds_read_b128 v[100:103], v16 offset:43008
    ds_read_b128 v[104:107], v16 offset:44032
    s_waitcnt lgkmcnt(8)
    v_mfma_f32_32x32x16_bf16 v[44:59], a[28:31], v[120:123], v[44:59]
    s_waitcnt lgkmcnt(7)
    v_mfma_f32_32x32x16_bf16 v[60:75], a[8:11], v[76:79], v[60:75]
    s_waitcnt lgkmcnt(6)
    v_mfma_f32_32x32x16_bf16 v[60:75], a[12:15], v[80:83], v[60:75]
    ds_read_b128 v[108:111], v16 offset:45056
    ds_read_b128 v[112:115], v16 offset:46080
    s_waitcnt lgkmcnt(7)
    v_mfma_f32_32x32x16_bf16 v[60:75], a[24:27], v[84:87], v[60:75]
    ds_read_b128 v[116:119], v16 offset:47104
    ds_read_b128 v[120:123], v16 offset:48128
    s_waitcnt lgkmcnt(8)
    v_mfma_f32_32x32x16_bf16 v[60:75], a[28:31], v[88:91], v[60:75]
    s_waitcnt lgkmcnt(7)
    v_mfma_f32_32x32x16_bf16 v[44:59], a[40:43], v[92:95], v[44:59]
    s_waitcnt lgkmcnt(6)
    v_mfma_f32_32x32x16_bf16 v[44:59], a[44:47], v[96:99], v[44:59]
    s_barrier
    ds_read_b128 v[76:79], v16 offset:49152
    ds_read_b128 v[80:83], v16 offset:50176
    s_waitcnt lgkmcnt(7)
    v_mfma_f32_32x32x16_bf16 v[44:59], a[56:59], v[100:103], v[44:59]
    ds_read_b128 v[84:87], v16 offset:51200
    ds_read_b128 v[88:91], v16 offset:52224
    s_waitcnt lgkmcnt(8)
    v_mfma_f32_32x32x16_bf16 v[44:59], a[60:63], v[104:107], v[44:59]
    s_waitcnt lgkmcnt(7)
    v_mfma_f32_32x32x16_bf16 v[60:75], a[40:43], v[108:111], v[60:75]
    s_waitcnt lgkmcnt(6)
    v_mfma_f32_32x32x16_bf16 v[60:75], a[44:47], v[112:115], v[60:75]
    ds_read_b128 v[92:95], v16 offset:53248
    ds_read_b128 v[96:99], v16 offset:54272
    s_waitcnt lgkmcnt(7)
    v_mfma_f32_32x32x16_bf16 v[60:75], a[56:59], v[116:119], v[60:75]
    ds_read_b128 v[100:103], v16 offset:55296
    ds_read_b128 v[104:107], v16 offset:56320
    s_waitcnt lgkmcnt(8)
    v_mfma_f32_32x32x16_bf16 v[60:75], a[60:63], v[120:123], v[60:75]
    s_waitcnt lgkmcnt(7)
    v_mfma_f32_32x32x16_bf16 v[44:59], a[72:75], v[76:79], v[44:59]
    s_waitcnt lgkmcnt(6)
    v_mfma_f32_32x32x16_bf16 v[44:59], a[76:79], v[80:83], v[44:59]
    s_barrier
    ds_read_b128 v[108:111], v16 offset:57344
    ds_read_b128 v[112:115], v16 offset:58368
    s_waitcnt lgkmcnt(7)
    v_mfma_f32_32x32x16_bf16 v[44:59], a[88:91], v[84:87], v[44:59]
    ds_read_b128 v[116:119], v16 offset:59392
    ds_read_b128 v[120:123], v16 offset:60416
    s_waitcnt lgkmcnt(8)
    v_mfma_f32_32x32x16_bf16 v[44:59], a[92:95], v[88:91], v[44:59]
    s_waitcnt lgkmcnt(7)
    v_mfma_f32_32x32x16_bf16 v[60:75], a[72:75], v[92:95], v[60:75]
    s_waitcnt lgkmcnt(6)
    v_mfma_f32_32x32x16_bf16 v[60:75], a[76:79], v[96:99], v[60:75]
    ds_read_b128 v[76:79], v16 offset:61440
    ds_read_b128 v[80:83], v16 offset:62464
    s_waitcnt lgkmcnt(7)
    v_mfma_f32_32x32x16_bf16 v[60:75], a[88:91], v[100:103], v[60:75]
    ds_read_b128 v[84:87], v16 offset:63488
    ds_read_b128 v[88:91], v16 offset:64512
    s_waitcnt lgkmcnt(8)
    v_mfma_f32_32x32x16_bf16 v[60:75], a[92:95], v[104:107], v[60:75]
    s_waitcnt lgkmcnt(7)
    v_mfma_f32_32x32x16_bf16 v[44:59], a[104:107], v[108:111], v[44:59]
    s_waitcnt lgkmcnt(6)
    v_mfma_f32_32x32x16_bf16 v[44:59], a[108:111], v[112:115], v[44:59]
    s_waitcnt lgkmcnt(5)
    v_mfma_f32_32x32x16_bf16 v[44:59], a[120:123], v[116:119], v[44:59]
    s_waitcnt lgkmcnt(4)
    v_mfma_f32_32x32x16_bf16 v[44:59], a[124:127], v[120:123], v[44:59]
    s_waitcnt lgkmcnt(3)
    v_mfma_f32_32x32x16_bf16 v[60:75], a[104:107], v[76:79], v[60:75]
    s_waitcnt lgkmcnt(2)
    v_mfma_f32_32x32x16_bf16 v[60:75], a[108:111], v[80:83], v[60:75]
    s_waitcnt lgkmcnt(1)
    v_mfma_f32_32x32x16_bf16 v[60:75], a[120:123], v[84:87], v[60:75]
    s_waitcnt lgkmcnt(0)
    v_mfma_f32_32x32x16_bf16 v[60:75], a[124:127], v[88:91], v[60:75]
L_ODONE:
    s_nop 11
    v_cmp_u_f32 vcc, v44, v60
    s_nop 4
    s_cbranch_vccnz L_OSLOW
L_OOK:
    v_cvt_pk_bf16_f32 v76, v44, v45
    v_cvt_pk_bf16_f32 v77, v46, v47
    v_cvt_pk_bf16_f32 v78, v48, v49
    v_cvt_pk_bf16_f32 v79, v50, v51
    ds_write_b128 v17, v[76:79] offset:0
    v_cvt_pk_bf16_f32 v80, v52, v53
    v_cvt_pk_bf16_f32 v81, v54, v55
    v_cvt_pk_bf16_f32 v82, v56, v57
    v_cvt_pk_bf16_f32 v83, v58, v59
    ds_write_b128 v17, v[80:83] offset:16
    v_cvt_pk_bf16_f32 v84, v60, v61
    v_cvt_pk_bf16_f32 v85, v62, v63
    v_cvt_pk_bf16_f32 v86, v64, v65
    v_cvt_pk_bf16_f32 v87, v66, v67
    ds_write_b128 v17, v[84:87] offset:8704
    v_cvt_pk_bf16_f32 v88, v68, v69
    v_cvt_pk_bf16_f32 v89, v70, v71
    v_cvt_pk_bf16_f32 v90, v72, v73
    v_cvt_pk_bf16_f32 v91, v74, v75
    ds_write_b128 v17, v[88:91] offset:8720
    s_waitcnt lgkmcnt(0)
    s_barrier
    ds_read_b128 v[92:95], v18 offset:0
    ds_read_b128 v[96:99], v18 offset:1088
    s_waitcnt lgkmcnt(1)
    buffer_store_dwordx4 v[92:95], v19, s[24:27], s42 offen sc1 nt
    s_waitcnt lgkmcnt(0)
    buffer_store_dwordx4 v[96:99], v19, s[24:27], s43 offen sc1 nt
    s_endpgm
L_SMK1:
    s_nop 11
    v_max3_f32 v116, v60, v61, v62
    v_max3_f32 v116, v116, v63, v64
    v_max3_f32 v116, v116, v65, v66
    v_max3_f32 v116, v116, v67, v68
    v_max3_f32 v116, v116, v69, v70
    v_max3_f32 v116, v116, v71, v72
    v_max3_f32 v116, v116, v73, v74
    v_max_f32 v116, v116, v75
    v_min3_f32 v117, v60, v61, v62
    v_min3_f32 v117, v117, v63, v64
    v_min3_f32 v117, v117, v65, v66
    v_min3_f32 v117, v117, v67, v68
    v_min3_f32 v117, v117, v69, v70
    v_min3_f32 v117, v117, v71, v72
    v_min3_f32 v117, v117, v73, v74
    v_min_f32 v117, v117, v75
    v_sub_f32 v92, v117, v60
    v_sub_f32 v93, v117, v61
    v_sub_f32 v94, v117, v62
    v_sub_f32 v95, v117, v63
    v_sub_f32 v96, v117, v64
    v_sub_f32 v97, v117, v65
    v_sub_f32 v98, v117, v66
    v_sub_f32 v99, v117, v67
    v_sub_f32 v100, v117, v68
    v_sub_f32 v101, v117, v69
    v_sub_f32 v102, v117, v70
    v_sub_f32 v103, v117, v71
    v_sub_f32 v104, v117, v72
    v_sub_f32 v105, v117, v73
    v_sub_f32 v106, v117, v74
    v_sub_f32 v107, v117, v75
    v_sub_f32 v60, v60, v116
    v_sub_f32 v61, v61, v116
    v_sub_f32 v62, v62, v116
    v_sub_f32 v63, v63, v116
    v_sub_f32 v64, v64, v116
    v_sub_f32 v65, v65, v116
    v_sub_f32 v66, v66, v116
    v_sub_f32 v67, v67, v116
    v_sub_f32 v68, v68, v116
    v_sub_f32 v69, v69, v116
    v_sub_f32 v70, v70, v116
    v_sub_f32 v71, v71, v116
    v_sub_f32 v72, v72, v116
    v_sub_f32 v73, v73, v116
    v_sub_f32 v74, v74, v116
    v_sub_f32 v75, v75, v116
    v_exp_f32 v92, v92
    v_exp_f32 v93, v93
    v_exp_f32 v94, v94
    v_exp_f32 v95, v95
    v_exp_f32 v96, v96
    v_exp_f32 v97, v97
    v_exp_f32 v98, v98
    v_exp_f32 v99, v99
    v_exp_f32 v100, v100
    v_exp_f32 v101, v101
    v_exp_f32 v102, v102
    v_exp_f32 v103, v103
    v_exp_f32 v104, v104
    v_exp_f32 v105, v105
    v_exp_f32 v106, v106
    v_exp_f32 v107, v107
    s_nop 2
    s_branch L_SMK1B
L_GB0:
    s_bitset1_b32 s45, 0
    s_add_u32 s42, s37, 4
    s_and_b32 s42, s42, 15
    s_lshl_b32 s42, s42, 10
    s_add_u32 s42, s42, s76
    buffer_load_dwordx4 v[44:47], v26, s[28:31], s42 offen sc1
    s_branch L_GB0R
L_GB1:
    s_bitset1_b32 s45, 1
    s_add_u32 s42, s37, 8
    s_and_b32 s42, s42, 15
    s_lshl_b32 s42, s42, 10
    s_add_u32 s42, s42, s76
    buffer_load_dwordx4 v[48:51], v26, s[28:31], s42 offen sc1
    s_branch L_GB1R
L_GB2:
    s_bitset1_b32 s45, 2
    s_add_u32 s42, s37, 12
    s_and_b32 s42, s42, 15
    s_lshl_b32 s42, s42, 10
    s_add_u32 s42, s42, s76
    buffer_load_dwordx4 v[52:55], v26, s[28:31], s42 offen sc1
    s_branch L_GB2R
L_GB3:
    s_bitset1_b32 s45, 3
    s_add_u32 s42, s37, 5
    s_and_b32 s42, s42, 15
    s_lshl_b32 s42, s42, 10
    s_add_u32 s42, s42, s76
    buffer_load_dwordx4 v[56:59], v26, s[28:31], s42 offen sc1
    s_branch L_GB3R
L_GB4:
    s_bitset1_b32 s45, 4
    s_add_u32 s42, s37, 9
    s_and_b32 s42, s42, 15
    s_lshl_b32 s42, s42, 10
    s_add_u32 s42, s42, s76
    buffer_load_dwordx4 v[60:63], v26, s[28:31], s42 offen sc1
    s_branch L_GB4R
L_GB5:
    s_bitset1_b32 s45, 5
    s_add_u32 s42, s37, 13
    s_and_b32 s42, s42, 15
    s_lshl_b32 s42, s42, 10
    s_add_u32 s42, s42, s76
    buffer_load_dwordx4 v[64:67], v26, s[28:31], s42 offen sc1
    s_branch L_GB5R
L_GB6:
    s_bitset1_b32 s45, 6
    s_add_u32 s42, s37, 6
    s_and_b32 s42, s42, 15
    s_lshl_b32 s42, s42, 10
    s_add_u32 s42, s42, s76
    buffer_load_dwordx4 v[68:71], v26, s[28:31], s42 offen sc1
    s_branch L_GB6R
L_GB7:
    s_bitset1_b32 s45, 7
    s_add_u32 s42, s37, 10
    s_and_b32 s42, s42, 15
    s_lshl_b32 s42, s42, 10
    s_add_u32 s42, s42, s76
    buffer_load_dwordx4 v[72:75], v26, s[28:31], s42 offen sc1
    s_branch L_GB7R
L_GB8:
    s_bitset1_b32 s45, 8
    s_add_u32 s42, s37, 14
    s_and_b32 s42, s42, 15
    s_lshl_b32 s42, s42, 10
    s_add_u32 s42, s42, s76
    buffer_load_dwordx4 v[76:79], v26, s[28:31], s42 offen sc1
    s_branch L_GB8R
L_GB9:
    s_bitset1_b32 s45, 9
    s_add_u32 s42, s37, 7
    s_and_b32 s42, s42, 15
    s_lshl_b32 s42, s42, 10
    s_add_u32 s42, s42, s76
    buffer_load_dwordx4 v[80:83], v26, s[28:31], s42 offen sc1
    s_branch L_GB9R
L_GB10:
    s_bitset1_b32 s45, 10
    s_add_u32 s42, s37, 11
    s_and_b32 s42, s42, 15
    s_lshl_b32 s42, s42, 10
    s_add_u32 s42, s42, s76
    buffer_load_dwordx4 v[84:87], v26, s[28:31], s42 offen sc1
    s_branch L_GB10R
L_GB11:
    s_bitset1_b32 s45, 11
    s_add_u32 s42, s37, 15
    s_and_b32 s42, s42, 15
    s_lshl_b32 s42, s42, 10
    s_add_u32 s42, s42, s76
    buffer_load_dwordx4 v[88:91], v26, s[28:31], s42 offen sc1
    s_branch L_GB11R
L_GB12:
    s_bitset1_b32 s45, 12
    s_add_u32 s42, s37, 1
    s_and_b32 s42, s42, 15
    s_lshl_b32 s42, s42, 10
    s_add_u32 s42, s42, s76
    buffer_load_dwordx4 v[92:95], v26, s[28:31], s42 offen sc1
    s_branch L_GB12R
L_GB13:
    s_bitset1_b32 s45, 13
    s_add_u32 s42, s37, 2
    s_and_b32 s42, s42, 15
    s_lshl_b32 s42, s42, 10
    s_add_u32 s42, s42, s76
    buffer_load_dwordx4 v[96:99], v26, s[28:31], s42 offen sc1
    s_branch L_GB13R
L_GB14:
    s_bitset1_b32 s45, 14
    s_add_u32 s42, s37, 3
    s_and_b32 s42, s42, 15
    s_lshl_b32 s42, s42, 10
    s_add_u32 s42, s42, s76
    buffer_load_dwordx4 v[100:103], v26, s[28:31], s42 offen sc1
    s_branch L_GB14R
L_GPEND:
    s_add_u32 s54, s54, 64
    s_mov_b32 s55, 0x4000
    buffer_load_dwordx2 v[108:109], v16, s[28:31], s77 offen offset:0 sc1
    buffer_load_dwordx2 v[110:111], v16, s[28:31], s77 offen offset:512 sc1
    buffer_load_dwordx2 v[112:113], v16, s[28:31], s77 offen offset:1024 sc1
    buffer_load_dwordx2 v[114:115], v16, s[28:31], s77 offen offset:1536 sc1
L_GPL:
    s_waitcnt vmcnt(0)
    s_bitcmp1_b32 s45, 0
    s_cbranch_scc0 L_GP0
    v_cmp_eq_u32 s[64:65], -1, v44
    s_nop 1
    s_cmp_lg_u64 s[64:65], 0
    s_cbranch_scc1 L_GP0B
    v_mfma_f32_32x32x16_bf16 a[112:127], v[36:39], v[44:47], a[112:127]
    s_bitset0_b32 s45, 0
    s_branch L_GP0
L_GP0B:
    s_add_u32 s42, s37, 4
    s_and_b32 s42, s42, 15
    s_lshl_b32 s42, s42, 10
    s_add_u32 s42, s42, s76
    buffer_load_dwordx4 v[44:47], v26, s[28:31], s42 offen sc1
L_GP0:
    s_bitcmp1_b32 s45, 1
    s_cbranch_scc0 L_GP1
    v_cmp_eq_u32 s[66:67], -1, v48
    s_nop 1
    s_cmp_lg_u64 s[66:67], 0
    s_cbranch_scc1 L_GP1B
    v_mfma_f32_32x32x16_bf16 a[112:127], v[36:39], v[48:51], a[112:127]
    s_bitset0_b32 s45, 1
    s_branch L_GP1
L_GP1B:
    s_add_u32 s42, s37, 8
    s_and_b32 s42, s42, 15
    s_lshl_b32 s42, s42, 10
    s_add_u32 s42, s42, s76
    buffer_load_dwordx4 v[48:51], v26, s[28:31], s42 offen sc1
L_GP1:
    s_bitcmp1_b32 s45, 2
    s_cbranch_scc0 L_GP2
    v_cmp_eq_u32 s[64:65], -1, v52
    s_nop 1
    s_cmp_lg_u64 s[64:65], 0
    s_cbranch_scc1 L_GP2B
    v_mfma_f32_32x32x16_bf16 a[112:127], v[36:39], v[52:55], a[112:127]
    s_bitset0_b32 s45, 2
    s_branch L_GP2
L_GP2B:
    s_add_u32 s42, s37, 12
    s_and_b32 s42, s42, 15
    s_lshl_b32 s42, s42, 10
    s_add_u32 s42, s42, s76
    buffer_load_dwordx4 v[52:55], v26, s[28:31], s42 offen sc1
L_GP2:
    s_bitcmp1_b32 s45, 3
    s_cbranch_scc0 L_GP3
    v_cmp_eq_u32 s[66:67], -1, v56
    s_nop 1
    s_cmp_lg_u64 s[66:67], 0
    s_cbranch_scc1 L_GP3B
    v_mfma_f32_32x32x16_bf16 a[112:127], v[36:39], v[56:59], a[112:127]
    s_bitset0_b32 s45, 3
    s_branch L_GP3
L_GP3B:
    s_add_u32 s42, s37, 5
    s_and_b32 s42, s42, 15
    s_lshl_b32 s42, s42, 10
    s_add_u32 s42, s42, s76
    buffer_load_dwordx4 v[56:59], v26, s[28:31], s42 offen sc1
L_GP3:
    s_bitcmp1_b32 s45, 4
    s_cbranch_scc0 L_GP4
    v_cmp_eq_u32 s[64:65], -1, v60
    s_nop 1
    s_cmp_lg_u64 s[64:65], 0
    s_cbranch_scc1 L_GP4B
    v_mfma_f32_32x32x16_bf16 a[112:127], v[36:39], v[60:63], a[112:127]
    s_bitset0_b32 s45, 4
    s_branch L_GP4
L_GP4B:
    s_add_u32 s42, s37, 9
    s_and_b32 s42, s42, 15
    s_lshl_b32 s42, s42, 10
    s_add_u32 s42, s42, s76
    buffer_load_dwordx4 v[60:63], v26, s[28:31], s42 offen sc1
L_GP4:
    s_bitcmp1_b32 s45, 5
    s_cbranch_scc0 L_GP5
    v_cmp_eq_u32 s[66:67], -1, v64
    s_nop 1
    s_cmp_lg_u64 s[66:67], 0
    s_cbranch_scc1 L_GP5B
    v_mfma_f32_32x32x16_bf16 a[112:127], v[36:39], v[64:67], a[112:127]
    s_bitset0_b32 s45, 5
    s_branch L_GP5
L_GP5B:
    s_add_u32 s42, s37, 13
    s_and_b32 s42, s42, 15
    s_lshl_b32 s42, s42, 10
    s_add_u32 s42, s42, s76
    buffer_load_dwordx4 v[64:67], v26, s[28:31], s42 offen sc1
L_GP5:
    s_bitcmp1_b32 s45, 6
    s_cbranch_scc0 L_GP6
    v_cmp_eq_u32 s[64:65], -1, v68
    s_nop 1
    s_cmp_lg_u64 s[64:65], 0
    s_cbranch_scc1 L_GP6B
    v_mfma_f32_32x32x16_bf16 a[112:127], v[36:39], v[68:71], a[112:127]
    s_bitset0_b32 s45, 6
    s_branch L_GP6
L_GP6B:
    s_add_u32 s42, s37, 6
    s_and_b32 s42, s42, 15
    s_lshl_b32 s42, s42, 10
    s_add_u32 s42, s42, s76
    buffer_load_dwordx4 v[68:71], v26, s[28:31], s42 offen sc1
L_GP6:
    s_bitcmp1_b32 s45, 7
    s_cbranch_scc0 L_GP7
    v_cmp_eq_u32 s[66:67], -1, v72
    s_nop 1
    s_cmp_lg_u64 s[66:67], 0
    s_cbranch_scc1 L_GP7B
    v_mfma_f32_32x32x16_bf16 a[112:127], v[36:39], v[72:75], a[112:127]
    s_bitset0_b32 s45, 7
    s_branch L_GP7
L_GP7B:
    s_add_u32 s42, s37, 10
    s_and_b32 s42, s42, 15
    s_lshl_b32 s42, s42, 10
    s_add_u32 s42, s42, s76
    buffer_load_dwordx4 v[72:75], v26, s[28:31], s42 offen sc1
L_GP7:
    s_bitcmp1_b32 s45, 8
    s_cbranch_scc0 L_GP8
    v_cmp_eq_u32 s[64:65], -1, v76
    s_nop 1
    s_cmp_lg_u64 s[64:65], 0
    s_cbranch_scc1 L_GP8B
    v_mfma_f32_32x32x16_bf16 a[112:127], v[36:39], v[76:79], a[112:127]
    s_bitset0_b32 s45, 8
    s_branch L_GP8
L_GP8B:
    s_add_u32 s42, s37, 14
    s_and_b32 s42, s42, 15
    s_lshl_b32 s42, s42, 10
    s_add_u32 s42, s42, s76
    buffer_load_dwordx4 v[76:79], v26, s[28:31], s42 offen sc1
L_GP8:
    s_bitcmp1_b32 s45, 9
    s_cbranch_scc0 L_GP9
    v_cmp_eq_u32 s[66:67], -1, v80
    s_nop 1
    s_cmp_lg_u64 s[66:67], 0
    s_cbranch_scc1 L_GP9B
    v_mfma_f32_32x32x16_bf16 a[112:127], v[36:39], v[80:83], a[112:127]
    s_bitset0_b32 s45, 9
    s_branch L_GP9
L_GP9B:
    s_add_u32 s42, s37, 7
    s_and_b32 s42, s42, 15
    s_lshl_b32 s42, s42, 10
    s_add_u32 s42, s42, s76
    buffer_load_dwordx4 v[80:83], v26, s[28:31], s42 offen sc1
L_GP9:
    s_bitcmp1_b32 s45, 10
    s_cbranch_scc0 L_GP10
    v_cmp_eq_u32 s[64:65], -1, v84
    s_nop 1
    s_cmp_lg_u64 s[64:65], 0
    s_cbranch_scc1 L_GP10B
    v_mfma_f32_32x32x16_bf16 a[112:127], v[36:39], v[84:87], a[112:127]
    s_bitset0_b32 s45, 10
    s_branch L_GP10
L_GP10B:
    s_add_u32 s42, s37, 11
    s_and_b32 s42, s42, 15
    s_lshl_b32 s42, s42, 10
    s_add_u32 s42, s42, s76
    buffer_load_dwordx4 v[84:87], v26, s[28:31], s42 offen sc1
L_GP10:
    s_bitcmp1_b32 s45, 11
    s_cbranch_scc0 L_GP11
    v_cmp_eq_u32 s[66:67], -1, v88
    s_nop 1
    s_cmp_lg_u64 s[66:67], 0
    s_cbranch_scc1 L_GP11B
    v_mfma_f32_32x32x16_bf16 a[112:127], v[36:39], v[88:91], a[112:127]
    s_bitset0_b32 s45, 11
    s_branch L_GP11
L_GP11B:
    s_add_u32 s42, s37, 15
    s_and_b32 s42, s42, 15
    s_lshl_b32 s42, s42, 10
    s_add_u32 s42, s42, s76
    buffer_load_dwordx4 v[88:91], v26, s[28:31], s42 offen sc1
L_GP11:
    s_bitcmp1_b32 s45, 12
    s_cbranch_scc0 L_GP12
    v_cmp_eq_u32 s[64:65], -1, v92
    s_nop 1
    s_cmp_lg_u64 s[64:65], 0
    s_cbranch_scc1 L_GP12B
    v_mfma_f32_32x32x16_bf16 a[112:127], v[36:39], v[92:95], a[112:127]
    s_bitset0_b32 s45, 12
    s_branch L_GP12
L_GP12B:
    s_add_u32 s42, s37, 1
    s_and_b32 s42, s42, 15
    s_lshl_b32 s42, s42, 10
    s_add_u32 s42, s42, s76
    buffer_load_dwordx4 v[92:95], v26, s[28:31], s42 offen sc1
L_GP12:
    s_bitcmp1_b32 s45, 13
    s_cbranch_scc0 L_GP13
    v_cmp_eq_u32 s[66:67], -1, v96
    s_nop 1
    s_cmp_lg_u64 s[66:67], 0
    s_cbranch_scc1 L_GP13B
    v_mfma_f32_32x32x16_bf16 a[112:127], v[36:39], v[96:99], a[112:127]
    s_bitset0_b32 s45, 13
    s_branch L_GP13
L_GP13B:
    s_add_u32 s42, s37, 2
    s_and_b32 s42, s42, 15
    s_lshl_b32 s42, s42, 10
    s_add_u32 s42, s42, s76
    buffer_load_dwordx4 v[96:99], v26, s[28:31], s42 offen sc1
L_GP13:
    s_bitcmp1_b32 s45, 14
    s_cbranch_scc0 L_GP14
    v_cmp_eq_u32 s[64:65], -1, v100
    s_nop 1
    s_cmp_lg_u64 s[64:65], 0
    s_cbranch_scc1 L_GP14B
    v_mfma_f32_32x32x16_bf16 a[112:127], v[36:39], v[100:103], a[112:127]
    s_bitset0_b32 s45, 14
    s_branch L_GP14
L_GP14B:
    s_add_u32 s42, s37, 3
    s_and_b32 s42, s42, 15
    s_lshl_b32 s42, s42, 10
    s_add_u32 s42, s42, s76
    buffer_load_dwordx4 v[100:103], v26, s[28:31], s42 offen sc1
L_GP14:
    s_cmp_eq_u32 s45, 0
    s_nop 3
    s_cbranch_scc1 L_ZSUM
    buffer_load_dwordx2 v[108:109], v16, s[28:31], s77 offen offset:0 sc1
    buffer_load_dwordx2 v[110:111], v16, s[28:31], s77 offen offset:512 sc1
    buffer_load_dwordx2 v[112:113], v16, s[28:31], s77 offen offset:1024 sc1
    buffer_load_dwordx2 v[114:115], v16, s[28:31], s77 offen offset:1536 sc1
    s_sub_u32 s55, s55, 1
    s_cbranch_scc0 L_GPL
    s_mov_b32 s45, 0
    s_waitcnt vmcnt(0)
    s_branch L_ZSUM
L_GSLOW:
    s_mov_b32 s55, 0x4000
    s_nop 11
L_GRETRY:
    v_max3_u32 v117, v44, v45, v46
    v_max3_u32 v117, v117, v47, v48
    v_max3_u32 v117, v117, v49, v50
    v_max3_u32 v117, v117, v51, v52
    v_max3_u32 v117, v117, v53, v54
    v_max3_u32 v117, v117, v55, v56
    v_max3_u32 v117, v117, v57, v58
    v_max3_u32 v117, v117, v59, v60
    v_max3_u32 v117, v117, v61, v62
    v_max3_u32 v117, v117, v63, v64
    v_max3_u32 v117, v117, v65, v66
    v_max3_u32 v117, v117, v67, v68
    v_max3_u32 v117, v117, v69, v70
    v_max3_u32 v117, v117, v71, v72
    v_max3_u32 v117, v117, v73, v74
    v_max3_u32 v117, v117, v75, v76
    v_max3_u32 v117, v117, v77, v78
    v_max3_u32 v117, v117, v79, v80
    v_max3_u32 v117, v117, v81, v82
    v_max3_u32 v117, v117, v83, v84
    v_max3_u32 v117, v117, v85, v86
    v_max3_u32 v117, v117, v87, v88
    v_max3_u32 v117, v117, v89, v90
    v_max3_u32 v117, v117, v91, v92
    v_max3_u32 v117, v117, v93, v94
    v_max3_u32 v117, v117, v95, v96
    v_max3_u32 v117, v117, v97, v98
    v_max3_u32 v117, v117, v99, v100
    v_max3_u32 v117, v117, v101, v102
    v_max3_u32 v117, v117, v103, v108
    v_max3_u32 v117, v117, v109, v110
    v_max3_u32 v117, v117, v111, v112
    v_max3_u32 v117, v117, v113, v114
    v_max_u32 v117, v117, v115
    v_cmp_eq_u32 vcc, -1, v117
    s_bitset1_b32 s54, 0
    s_nop 3
    s_cbranch_vccz L_GDONE
    s_sub_u32 s55, s55, 1
    s_cbranch_scc1 L_GDONE
    s_add_u32 s42, s37, 4
    s_and_b32 s42, s42, 15
    s_lshl_b32 s42, s42, 10
    s_add_u32 s42, s42, s76
    buffer_load_dwordx4 v[44:47], v26, s[28:31], s42 offen sc1
    s_add_u32 s42, s37, 8
    s_and_b32 s42, s42, 15
    s_lshl_b32 s42, s42, 10
    s_add_u32 s42, s42, s76
    buffer_load_dwordx4 v[48:51], v26, s[28:31], s42 offen sc1
    s_add_u32 s42, s37, 12
    s_and_b32 s42, s42, 15
    s_lshl_b32 s42, s42, 10
    s_add_u32 s42, s42, s76
    buffer_load_dwordx4 v[52:55], v26, s[28:31], s42 offen sc1
    s_add_u32 s42, s37, 5
    s_and_b32 s42, s42, 15
    s_lshl_b32 s42, s42, 10
    s_add_u32 s42, s42, s76
    buffer_load_dwordx4 v[56:59], v26, s[28:31], s42 offen sc1
    s_add_u32 s42, s37, 9
    s_and_b32 s42, s42, 15
    s_lshl_b32 s42, s42, 10
    s_add_u32 s42, s42, s76
    buffer_load_dwordx4 v[60:63], v26, s[28:31], s42 offen sc1
    s_add_u32 s42, s37, 13
    s_and_b32 s42, s42, 15
    s_lshl_b32 s42, s42, 10
    s_add_u32 s42, s42, s76
    buffer_load_dwordx4 v[64:67], v26, s[28:31], s42 offen sc1
    s_add_u32 s42, s37, 6
    s_and_b32 s42, s42, 15
    s_lshl_b32 s42, s42, 10
    s_add_u32 s42, s42, s76
    buffer_load_dwordx4 v[68:71], v26, s[28:31], s42 offen sc1
    s_add_u32 s42, s37, 10
    s_and_b32 s42, s42, 15
    s_lshl_b32 s42, s42, 10
    s_add_u32 s42, s42, s76
    buffer_load_dwordx4 v[72:75], v26, s[28:31], s42 offen sc1
    s_add_u32 s42, s37, 14
    s_and_b32 s42, s42, 15
    s_lshl_b32 s42, s42, 10
    s_add_u32 s42, s42, s76
    buffer_load_dwordx4 v[76:79], v26, s[28:31], s42 offen sc1
    s_add_u32 s42, s37, 7
    s_and_b32 s42, s42, 15
    s_lshl_b32 s42, s42, 10
    s_add_u32 s42, s42, s76
    buffer_load_dwordx4 v[80:83], v26, s[28:31], s42 offen sc1
    s_add_u32 s42, s37, 11
    s_and_b32 s42, s42, 15
    s_lshl_b32 s42, s42, 10
    s_add_u32 s42, s42, s76
    buffer_load_dwordx4 v[84:87], v26, s[28:31], s42 offen sc1
    s_add_u32 s42, s37, 15
    s_and_b32 s42, s42, 15
    s_lshl_b32 s42, s42, 10
    s_add_u32 s42, s42, s76
    buffer_load_dwordx4 v[88:91], v26, s[28:31], s42 offen sc1
    s_add_u32 s42, s37, 1
    s_and_b32 s42, s42, 15
    s_lshl_b32 s42, s42, 10
    s_add_u32 s42, s42, s76
    buffer_load_dwordx4 v[92:95], v26, s[28:31], s42 offen sc1
    s_add_u32 s42, s37, 2
    s_and_b32 s42, s42, 15
    s_lshl_b32 s42, s42, 10
    s_add_u32 s42, s42, s76
    buffer_load_dwordx4 v[96:99], v26, s[28:31], s42 offen sc1
    s_add_u32 s42, s37, 3
    s_and_b32 s42, s42, 15
    s_lshl_b32 s42, s42, 10
    s_add_u32 s42, s42, s76
    buffer_load_dwordx4 v[100:103], v26, s[28:31], s42 offen sc1
    buffer_load_dwordx2 v[108:109], v16, s[28:31], s77 offen offset:0 sc1
    buffer_load_dwordx2 v[110:111], v16, s[28:31], s77 offen offset:512 sc1
    buffer_load_dwordx2 v[112:113], v16, s[28:31], s77 offen offset:1024 sc1
    buffer_load_dwordx2 v[114:115], v16, s[28:31], s77 offen offset:1536 sc1
    s_waitcnt vmcnt(0)
    s_branch L_GRETRY
L_GDONE:
    v_mfma_f32_32x32x16_bf16 a[112:127], v[36:39], v[124:127], 0
    v_mfma_f32_32x32x16_bf16 a[112:127], v[36:39], v[44:47], a[112:127]
    v_mfma_f32_32x32x16_bf16 a[112:127], v[36:39], v[48:51], a[112:127]
    v_mfma_f32_32x32x16_bf16 a[112:127], v[36:39], v[52:55], a[112:127]
    v_mfma_f32_32x32x16_bf16 a[112:127], v[36:39], v[56:59], a[112:127]
    v_mfma_f32_32x32x16_bf16 a[112:127], v[36:39], v[60:63], a[112:127]
    v_mfma_f32_32x32x16_bf16 a[112:127], v[36:39], v[64:67], a[112:127]
    v_mfma_f32_32x32x16_bf16 a[112:127], v[36:39], v[68:71], a[112:127]
    v_mfma_f32_32x32x16_bf16 a[112:127], v[36:39], v[72:75], a[112:127]
    v_mfma_f32_32x32x16_bf16 a[112:127], v[36:39], v[76:79], a[112:127]
    v_mfma_f32_32x32x16_bf16 a[112:127], v[36:39], v[80:83], a[112:127]
    v_mfma_f32_32x32x16_bf16 a[112:127], v[36:39], v[84:87], a[112:127]
    v_mfma_f32_32x32x16_bf16 a[112:127], v[36:39], v[88:91], a[112:127]
    v_mfma_f32_32x32x16_bf16 a[112:127], v[36:39], v[92:95], a[112:127]
    v_mfma_f32_32x32x16_bf16 a[112:127], v[36:39], v[96:99], a[112:127]
    v_mfma_f32_32x32x16_bf16 a[112:127], v[36:39], v[100:103], a[112:127]
    s_nop 11
    s_branch L_ZSUM
L_OSLOW:
    s_add_u32 s54, s54, 2
    s_mov_b32 s55, 0x4000
    s_waitcnt lgkmcnt(0)
    s_nop 11
    v_mov_b32 v44, 0
    v_mov_b32 v45, 0
    v_mov_b32 v46, 0
    v_mov_b32 v47, 0
    v_mov_b32 v48, 0
    v_mov_b32 v49, 0
    v_mov_b32 v50, 0
    v_mov_b32 v51, 0
    v_mov_b32 v52, 0
    v_mov_b32 v53, 0
    v_mov_b32 v54, 0
    v_mov_b32 v55, 0
    v_mov_b32 v56, 0
    v_mov_b32 v57, 0
    v_mov_b32 v58, 0
    v_mov_b32 v59, 0
    v_mov_b32 v60, 0
    v_mov_b32 v61, 0
    v_mov_b32 v62, 0
    v_mov_b32 v63, 0
    v_mov_b32 v64, 0
    v_mov_b32 v65, 0
    v_mov_b32 v66, 0
    v_mov_b32 v67, 0
    v_mov_b32 v68, 0
    v_mov_b32 v69, 0
    v_mov_b32 v70, 0
    v_mov_b32 v71, 0
    v_mov_b32 v72, 0
    v_mov_b32 v73, 0
    v_mov_b32 v74, 0
    v_mov_b32 v75, 0
    v_add_u32 v6, 0x8000, v26
L_OR0:
    buffer_load_dwordx4 v[76:79], v26, s[28:31], s64 offen offset:0 sc1
    buffer_load_dwordx4 v[80:83], v26, s[28:31], s64 offen offset:1024 sc1
    buffer_load_dwordx4 v[84:87], v26, s[28:31], s65 offen offset:0 sc1
    buffer_load_dwordx4 v[88:91], v26, s[28:31], s65 offen offset:1024 sc1
    s_waitcnt vmcnt(3)
    v_max3_u32 v4, v76, v77, v78
    s_waitcnt vmcnt(2)
    v_max3_u32 v4, v4, v79, v80
    v_max3_u32 v4, v4, v81, v82
    s_waitcnt vmcnt(1)
    v_max3_u32 v4, v4, v83, v84
    v_max3_u32 v4, v4, v85, v86
    s_waitcnt vmcnt(0)
    v_max3_u32 v4, v4, v87, v88
    v_max3_u32 v4, v4, v89, v90
    v_max_u32 v4, v4, v91
    v_cmp_eq_u32 vcc, -1, v4
    s_sub_u32 s55, s55, 1
    s_cbranch_scc1 L_OG0
    s_nop 2
    s_cbranch_vccnz L_OR0
L_OG0:
    v_mfma_f32_32x32x16_bf16 v[44:59], a[0:3], v[76:79], v[44:59]
    v_mfma_f32_32x32x16_bf16 v[44:59], a[4:7], v[80:83], v[44:59]
    v_mfma_f32_32x32x16_bf16 v[44:59], a[16:19], v[84:87], v[44:59]
    v_mfma_f32_32x32x16_bf16 v[44:59], a[20:23], v[88:91], v[44:59]
L_OR1:
    buffer_load_dwordx4 v[92:95], v6, s[28:31], s64 offen offset:0 sc1
    buffer_load_dwordx4 v[96:99], v6, s[28:31], s64 offen offset:1024 sc1
    buffer_load_dwordx4 v[100:103], v6, s[28:31], s65 offen offset:0 sc1
    buffer_load_dwordx4 v[104:107], v6, s[28:31], s65 offen offset:1024 sc1
    s_waitcnt vmcnt(3)
    v_max3_u32 v4, v92, v93, v94
    s_waitcnt vmcnt(2)
    v_max3_u32 v4, v4, v95, v96
    v_max3_u32 v4, v4, v97, v98
    s_waitcnt vmcnt(1)
    v_max3_u32 v4, v4, v99, v100
    v_max3_u32 v4, v4, v101, v102
    s_waitcnt vmcnt(0)
    v_max3_u32 v4, v4, v103, v104
    v_max3_u32 v4, v4, v105, v106
    v_max_u32 v4, v4, v107
    v_cmp_eq_u32 vcc, -1, v4
    s_sub_u32 s55, s55, 1
    s_cbranch_scc1 L_OG1
    s_nop 2
    s_cbranch_vccnz L_OR1
L_OG1:
    v_mfma_f32_32x32x16_bf16 v[60:75], a[0:3], v[92:95], v[60:75]
    v_mfma_f32_32x32x16_bf16 v[60:75], a[4:7], v[96:99], v[60:75]
    v_mfma_f32_32x32x16_bf16 v[60:75], a[16:19], v[100:103], v[60:75]
    v_mfma_f32_32x32x16_bf16 v[60:75], a[20:23], v[104:107], v[60:75]
L_OR2:
    buffer_load_dwordx4 v[108:111], v26, s[28:31], s66 offen offset:0 sc1
    buffer_load_dwordx4 v[112:115], v26, s[28:31], s66 offen offset:1024 sc1
    buffer_load_dwordx4 v[116:119], v26, s[28:31], s67 offen offset:0 sc1
    buffer_load_dwordx4 v[120:123], v26, s[28:31], s67 offen offset:1024 sc1
    s_waitcnt vmcnt(3)
    v_max3_u32 v4, v108, v109, v110
    s_waitcnt vmcnt(2)
    v_max3_u32 v4, v4, v111, v112
    v_max3_u32 v4, v4, v113, v114
    s_waitcnt vmcnt(1)
    v_max3_u32 v4, v4, v115, v116
    v_max3_u32 v4, v4, v117, v118
    s_waitcnt vmcnt(0)
    v_max3_u32 v4, v4, v119, v120
    v_max3_u32 v4, v4, v121, v122
    v_max_u32 v4, v4, v123
    v_cmp_eq_u32 vcc, -1, v4
    s_sub_u32 s55, s55, 1
    s_cbranch_scc1 L_OG2
    s_nop 2
    s_cbranch_vccnz L_OR2
L_OG2:
    v_mfma_f32_32x32x16_bf16 v[44:59], a[32:35], v[108:111], v[44:59]
    v_mfma_f32_32x32x16_bf16 v[44:59], a[36:39], v[112:115], v[44:59]
    v_mfma_f32_32x32x16_bf16 v[44:59], a[48:51], v[116:119], v[44:59]
    v_mfma_f32_32x32x16_bf16 v[44:59], a[52:55], v[120:123], v[44:59]
L_OR3:
    buffer_load_dwordx4 v[76:79], v6, s[28:31], s66 offen offset:0 sc1
    buffer_load_dwordx4 v[80:83], v6, s[28:31], s66 offen offset:1024 sc1
    buffer_load_dwordx4 v[84:87], v6, s[28:31], s67 offen offset:0 sc1
    buffer_load_dwordx4 v[88:91], v6, s[28:31], s67 offen offset:1024 sc1
    s_waitcnt vmcnt(3)
    v_max3_u32 v4, v76, v77, v78
    s_waitcnt vmcnt(2)
    v_max3_u32 v4, v4, v79, v80
    v_max3_u32 v4, v4, v81, v82
    s_waitcnt vmcnt(1)
    v_max3_u32 v4, v4, v83, v84
    v_max3_u32 v4, v4, v85, v86
    s_waitcnt vmcnt(0)
    v_max3_u32 v4, v4, v87, v88
    v_max3_u32 v4, v4, v89, v90
    v_max_u32 v4, v4, v91
    v_cmp_eq_u32 vcc, -1, v4
    s_sub_u32 s55, s55, 1
    s_cbranch_scc1 L_OG3
    s_nop 2
    s_cbranch_vccnz L_OR3
L_OG3:
    v_mfma_f32_32x32x16_bf16 v[60:75], a[32:35], v[76:79], v[60:75]
    v_mfma_f32_32x32x16_bf16 v[60:75], a[36:39], v[80:83], v[60:75]
    v_mfma_f32_32x32x16_bf16 v[60:75], a[48:51], v[84:87], v[60:75]
    v_mfma_f32_32x32x16_bf16 v[60:75], a[52:55], v[88:91], v[60:75]
L_OR4:
    buffer_load_dwordx4 v[92:95], v26, s[28:31], s68 offen offset:0 sc1
    buffer_load_dwordx4 v[96:99], v26, s[28:31], s68 offen offset:1024 sc1
    buffer_load_dwordx4 v[100:103], v26, s[28:31], s69 offen offset:0 sc1
    buffer_load_dwordx4 v[104:107], v26, s[28:31], s69 offen offset:1024 sc1
    s_waitcnt vmcnt(3)
    v_max3_u32 v4, v92, v93, v94
    s_waitcnt vmcnt(2)
    v_max3_u32 v4, v4, v95, v96
    v_max3_u32 v4, v4, v97, v98
    s_waitcnt vmcnt(1)
    v_max3_u32 v4, v4, v99, v100
    v_max3_u32 v4, v4, v101, v102
    s_waitcnt vmcnt(0)
    v_max3_u32 v4, v4, v103, v104
    v_max3_u32 v4, v4, v105, v106
    v_max_u32 v4, v4, v107
    v_cmp_eq_u32 vcc, -1, v4
    s_sub_u32 s55, s55, 1
    s_cbranch_scc1 L_OG4
    s_nop 2
    s_cbranch_vccnz L_OR4
L_OG4:
    v_mfma_f32_32x32x16_bf16 v[44:59], a[64:67], v[92:95], v[44:59]
    v_mfma_f32_32x32x16_bf16 v[44:59], a[68:71], v[96:99], v[44:59]
    v_mfma_f32_32x32x16_bf16 v[44:59], a[80:83], v[100:103], v[44:59]
    v_mfma_f32_32x32x16_bf16 v[44:59], a[84:87], v[104:107], v[44:59]
L_OR5:
    buffer_load_dwordx4 v[108:111], v6, s[28:31], s68 offen offset:0 sc1
    buffer_load_dwordx4 v[112:115], v6, s[28:31], s68 offen offset:1024 sc1
    buffer_load_dwordx4 v[116:119], v6, s[28:31], s69 offen offset:0 sc1
    buffer_load_dwordx4 v[120:123], v6, s[28:31], s69 offen offset:1024 sc1
    s_waitcnt vmcnt(3)
    v_max3_u32 v4, v108, v109, v110
    s_waitcnt vmcnt(2)
    v_max3_u32 v4, v4, v111, v112
    v_max3_u32 v4, v4, v113, v114
    s_waitcnt vmcnt(1)
    v_max3_u32 v4, v4, v115, v116
    v_max3_u32 v4, v4, v117, v118
    s_waitcnt vmcnt(0)
    v_max3_u32 v4, v4, v119, v120
    v_max3_u32 v4, v4, v121, v122
    v_max_u32 v4, v4, v123
    v_cmp_eq_u32 vcc, -1, v4
    s_sub_u32 s55, s55, 1
    s_cbranch_scc1 L_OG5
    s_nop 2
    s_cbranch_vccnz L_OR5
L_OG5:
    v_mfma_f32_32x32x16_bf16 v[60:75], a[64:67], v[108:111], v[60:75]
    v_mfma_f32_32x32x16_bf16 v[60:75], a[68:71], v[112:115], v[60:75]
    v_mfma_f32_32x32x16_bf16 v[60:75], a[80:83], v[116:119], v[60:75]
    v_mfma_f32_32x32x16_bf16 v[60:75], a[84:87], v[120:123], v[60:75]
L_OR6:
    buffer_load_dwordx4 v[76:79], v26, s[28:31], s70 offen offset:0 sc1
    buffer_load_dwordx4 v[80:83], v26, s[28:31], s70 offen offset:1024 sc1
    buffer_load_dwordx4 v[84:87], v26, s[28:31], s71 offen offset:0 sc1
    buffer_load_dwordx4 v[88:91], v26, s[28:31], s71 offen offset:1024 sc1
    s_waitcnt vmcnt(3)
    v_max3_u32 v4, v76, v77, v78
    s_waitcnt vmcnt(2)
    v_max3_u32 v4, v4, v79, v80
    v_max3_u32 v4, v4, v81, v82
    s_waitcnt vmcnt(1)
    v_max3_u32 v4, v4, v83, v84
    v_max3_u32 v4, v4, v85, v86
    s_waitcnt vmcnt(0)
    v_max3_u32 v4, v4, v87, v88
    v_max3_u32 v4, v4, v89, v90
    v_max_u32 v4, v4, v91
    v_cmp_eq_u32 vcc, -1, v4
    s_sub_u32 s55, s55, 1
    s_cbranch_scc1 L_OG6
    s_nop 2
    s_cbranch_vccnz L_OR6
L_OG6:
    v_mfma_f32_32x32x16_bf16 v[44:59], a[96:99], v[76:79], v[44:59]
    v_mfma_f32_32x32x16_bf16 v[44:59], a[100:103], v[80:83], v[44:59]
    v_mfma_f32_32x32x16_bf16 v[44:59], a[112:115], v[84:87], v[44:59]
    v_mfma_f32_32x32x16_bf16 v[44:59], a[116:119], v[88:91], v[44:59]
L_OR7:
    buffer_load_dwordx4 v[92:95], v6, s[28:31], s70 offen offset:0 sc1
    buffer_load_dwordx4 v[96:99], v6, s[28:31], s70 offen offset:1024 sc1
    buffer_load_dwordx4 v[100:103], v6, s[28:31], s71 offen offset:0 sc1
    buffer_load_dwordx4 v[104:107], v6, s[28:31], s71 offen offset:1024 sc1
    s_waitcnt vmcnt(3)
    v_max3_u32 v4, v92, v93, v94
    s_waitcnt vmcnt(2)
    v_max3_u32 v4, v4, v95, v96
    v_max3_u32 v4, v4, v97, v98
    s_waitcnt vmcnt(1)
    v_max3_u32 v4, v4, v99, v100
    v_max3_u32 v4, v4, v101, v102
    s_waitcnt vmcnt(0)
    v_max3_u32 v4, v4, v103, v104
    v_max3_u32 v4, v4, v105, v106
    v_max_u32 v4, v4, v107
    v_cmp_eq_u32 vcc, -1, v4
    s_sub_u32 s55, s55, 1
    s_cbranch_scc1 L_OG7
    s_nop 2
    s_cbranch_vccnz L_OR7
L_OG7:
    v_mfma_f32_32x32x16_bf16 v[60:75], a[96:99], v[92:95], v[60:75]
    v_mfma_f32_32x32x16_bf16 v[60:75], a[100:103], v[96:99], v[60:75]
    v_mfma_f32_32x32x16_bf16 v[60:75], a[112:115], v[100:103], v[60:75]
    v_mfma_f32_32x32x16_bf16 v[60:75], a[116:119], v[104:107], v[60:75]
L_OR8:
    buffer_load_dwordx4 v[108:111], v26, s[28:31], s64 offen offset:2048 sc1
    buffer_load_dwordx4 v[112:115], v26, s[28:31], s64 offen offset:3072 sc1
    buffer_load_dwordx4 v[116:119], v26, s[28:31], s65 offen offset:2048 sc1
    buffer_load_dwordx4 v[120:123], v26, s[28:31], s65 offen offset:3072 sc1
    s_waitcnt vmcnt(3)
    v_max3_u32 v4, v108, v109, v110
    s_waitcnt vmcnt(2)
    v_max3_u32 v4, v4, v111, v112
    v_max3_u32 v4, v4, v113, v114
    s_waitcnt vmcnt(1)
    v_max3_u32 v4, v4, v115, v116
    v_max3_u32 v4, v4, v117, v118
    s_waitcnt vmcnt(0)
    v_max3_u32 v4, v4, v119, v120
    v_max3_u32 v4, v4, v121, v122
    v_max_u32 v4, v4, v123
    v_cmp_eq_u32 vcc, -1, v4
    s_sub_u32 s55, s55, 1
    s_cbranch_scc1 L_OG8
    s_nop 2
    s_cbranch_vccnz L_OR8
L_OG8:
    v_mfma_f32_32x32x16_bf16 v[44:59], a[8:11], v[108:111], v[44:59]
    v_mfma_f32_32x32x16_bf16 v[44:59], a[12:15], v[112:115], v[44:59]
    v_mfma_f32_32x32x16_bf16 v[44:59], a[24:27], v[116:119], v[44:59]
    v_mfma_f32_32x32x16_bf16 v[44:59], a[28:31], v[120:123], v[44:59]
L_OR9:
    buffer_load_dwordx4 v[76:79], v6, s[28:31], s64 offen offset:2048 sc1
    buffer_load_dwordx4 v[80:83], v6, s[28:31], s64 offen offset:3072 sc1
    buffer_load_dwordx4 v[84:87], v6, s[28:31], s65 offen offset:2048 sc1
    buffer_load_dwordx4 v[88:91], v6, s[28:31], s65 offen offset:3072 sc1
    s_waitcnt vmcnt(3)
    v_max3_u32 v4, v76, v77, v78
    s_waitcnt vmcnt(2)
    v_max3_u32 v4, v4, v79, v80
    v_max3_u32 v4, v4, v81, v82
    s_waitcnt vmcnt(1)
    v_max3_u32 v4, v4, v83, v84
    v_max3_u32 v4, v4, v85, v86
    s_waitcnt vmcnt(0)
    v_max3_u32 v4, v4, v87, v88
    v_max3_u32 v4, v4, v89, v90
    v_max_u32 v4, v4, v91
    v_cmp_eq_u32 vcc, -1, v4
    s_sub_u32 s55, s55, 1
    s_cbranch_scc1 L_OG9
    s_nop 2
    s_cbranch_vccnz L_OR9
L_OG9:
    v_mfma_f32_32x32x16_bf16 v[60:75], a[8:11], v[76:79], v[60:75]
    v_mfma_f32_32x32x16_bf16 v[60:75], a[12:15], v[80:83], v[60:75]
    v_mfma_f32_32x32x16_bf16 v[60:75], a[24:27], v[84:87], v[60:75]
    v_mfma_f32_32x32x16_bf16 v[60:75], a[28:31], v[88:91], v[60:75]
L_OR10:
    buffer_load_dwordx4 v[92:95], v26, s[28:31], s66 offen offset:2048 sc1
    buffer_load_dwordx4 v[96:99], v26, s[28:31], s66 offen offset:3072 sc1
    buffer_load_dwordx4 v[100:103], v26, s[28:31], s67 offen offset:2048 sc1
    buffer_load_dwordx4 v[104:107], v26, s[28:31], s67 offen offset:3072 sc1
    s_waitcnt vmcnt(3)
    v_max3_u32 v4, v92, v93, v94
    s_waitcnt vmcnt(2)
    v_max3_u32 v4, v4, v95, v96
    v_max3_u32 v4, v4, v97, v98
    s_waitcnt vmcnt(1)
    v_max3_u32 v4, v4, v99, v100
    v_max3_u32 v4, v4, v101, v102
    s_waitcnt vmcnt(0)
    v_max3_u32 v4, v4, v103, v104
    v_max3_u32 v4, v4, v105, v106
    v_max_u32 v4, v4, v107
    v_cmp_eq_u32 vcc, -1, v4
    s_sub_u32 s55, s55, 1
    s_cbranch_scc1 L_OG10
    s_nop 2
    s_cbranch_vccnz L_OR10
L_OG10:
    v_mfma_f32_32x32x16_bf16 v[44:59], a[40:43], v[92:95], v[44:59]
    v_mfma_f32_32x32x16_bf16 v[44:59], a[44:47], v[96:99], v[44:59]
    v_mfma_f32_32x32x16_bf16 v[44:59], a[56:59], v[100:103], v[44:59]
    v_mfma_f32_32x32x16_bf16 v[44:59], a[60:63], v[104:107], v[44:59]
L_OR11:
    buffer_load_dwordx4 v[108:111], v6, s[28:31], s66 offen offset:2048 sc1
    buffer_load_dwordx4 v[112:115], v6, s[28:31], s66 offen offset:3072 sc1
    buffer_load_dwordx4 v[116:119], v6, s[28:31], s67 offen offset:2048 sc1
    buffer_load_dwordx4 v[120:123], v6, s[28:31], s67 offen offset:3072 sc1
    s_waitcnt vmcnt(3)
    v_max3_u32 v4, v108, v109, v110
    s_waitcnt vmcnt(2)
    v_max3_u32 v4, v4, v111, v112
    v_max3_u32 v4, v4, v113, v114
    s_waitcnt vmcnt(1)
    v_max3_u32 v4, v4, v115, v116
    v_max3_u32 v4, v4, v117, v118
    s_waitcnt vmcnt(0)
    v_max3_u32 v4, v4, v119, v120
    v_max3_u32 v4, v4, v121, v122
    v_max_u32 v4, v4, v123
    v_cmp_eq_u32 vcc, -1, v4
    s_sub_u32 s55, s55, 1
    s_cbranch_scc1 L_OG11
    s_nop 2
    s_cbranch_vccnz L_OR11
L_OG11:
    v_mfma_f32_32x32x16_bf16 v[60:75], a[40:43], v[108:111], v[60:75]
    v_mfma_f32_32x32x16_bf16 v[60:75], a[44:47], v[112:115], v[60:75]
    v_mfma_f32_32x32x16_bf16 v[60:75], a[56:59], v[116:119], v[60:75]
    v_mfma_f32_32x32x16_bf16 v[60:75], a[60:63], v[120:123], v[60:75]
L_OR12:
    buffer_load_dwordx4 v[76:79], v26, s[28:31], s68 offen offset:2048 sc1
    buffer_load_dwordx4 v[80:83], v26, s[28:31], s68 offen offset:3072 sc1
    buffer_load_dwordx4 v[84:87], v26, s[28:31], s69 offen offset:2048 sc1
    buffer_load_dwordx4 v[88:91], v26, s[28:31], s69 offen offset:3072 sc1
    s_waitcnt vmcnt(3)
    v_max3_u32 v4, v76, v77, v78
    s_waitcnt vmcnt(2)
    v_max3_u32 v4, v4, v79, v80
    v_max3_u32 v4, v4, v81, v82
    s_waitcnt vmcnt(1)
    v_max3_u32 v4, v4, v83, v84
    v_max3_u32 v4, v4, v85, v86
    s_waitcnt vmcnt(0)
    v_max3_u32 v4, v4, v87, v88
    v_max3_u32 v4, v4, v89, v90
    v_max_u32 v4, v4, v91
    v_cmp_eq_u32 vcc, -1, v4
    s_sub_u32 s55, s55, 1
    s_cbranch_scc1 L_OG12
    s_nop 2
    s_cbranch_vccnz L_OR12
L_OG12:
    v_mfma_f32_32x32x16_bf16 v[44:59], a[72:75], v[76:79], v[44:59]
    v_mfma_f32_32x32x16_bf16 v[44:59], a[76:79], v[80:83], v[44:59]
    v_mfma_f32_32x32x16_bf16 v[44:59], a[88:91], v[84:87], v[44:59]
    v_mfma_f32_32x32x16_bf16 v[44:59], a[92:95], v[88:91], v[44:59]
L_OR13:
    buffer_load_dwordx4 v[92:95], v6, s[28:31], s68 offen offset:2048 sc1
    buffer_load_dwordx4 v[96:99], v6, s[28:31], s68 offen offset:3072 sc1
    buffer_load_dwordx4 v[100:103], v6, s[28:31], s69 offen offset:2048 sc1
    buffer_load_dwordx4 v[104:107], v6, s[28:31], s69 offen offset:3072 sc1
    s_waitcnt vmcnt(3)
    v_max3_u32 v4, v92, v93, v94
    s_waitcnt vmcnt(2)
    v_max3_u32 v4, v4, v95, v96
    v_max3_u32 v4, v4, v97, v98
    s_waitcnt vmcnt(1)
    v_max3_u32 v4, v4, v99, v100
    v_max3_u32 v4, v4, v101, v102
    s_waitcnt vmcnt(0)
    v_max3_u32 v4, v4, v103, v104
    v_max3_u32 v4, v4, v105, v106
    v_max_u32 v4, v4, v107
    v_cmp_eq_u32 vcc, -1, v4
    s_sub_u32 s55, s55, 1
    s_cbranch_scc1 L_OG13
    s_nop 2
    s_cbranch_vccnz L_OR13
L_OG13:
    v_mfma_f32_32x32x16_bf16 v[60:75], a[72:75], v[92:95], v[60:75]
    v_mfma_f32_32x32x16_bf16 v[60:75], a[76:79], v[96:99], v[60:75]
    v_mfma_f32_32x32x16_bf16 v[60:75], a[88:91], v[100:103], v[60:75]
    v_mfma_f32_32x32x16_bf16 v[60:75], a[92:95], v[104:107], v[60:75]
L_OR14:
    buffer_load_dwordx4 v[108:111], v26, s[28:31], s70 offen offset:2048 sc1
    buffer_load_dwordx4 v[112:115], v26, s[28:31], s70 offen offset:3072 sc1
    buffer_load_dwordx4 v[116:119], v26, s[28:31], s71 offen offset:2048 sc1
    buffer_load_dwordx4 v[120:123], v26, s[28:31], s71 offen offset:3072 sc1
    s_waitcnt vmcnt(3)
    v_max3_u32 v4, v108, v109, v110
    s_waitcnt vmcnt(2)
    v_max3_u32 v4, v4, v111, v112
    v_max3_u32 v4, v4, v113, v114
    s_waitcnt vmcnt(1)
    v_max3_u32 v4, v4, v115, v116
    v_max3_u32 v4, v4, v117, v118
    s_waitcnt vmcnt(0)
    v_max3_u32 v4, v4, v119, v120
    v_max3_u32 v4, v4, v121, v122
    v_max_u32 v4, v4, v123
    v_cmp_eq_u32 vcc, -1, v4
    s_sub_u32 s55, s55, 1
    s_cbranch_scc1 L_OG14
    s_nop 2
    s_cbranch_vccnz L_OR14
L_OG14:
    v_mfma_f32_32x32x16_bf16 v[44:59], a[104:107], v[108:111], v[44:59]
    v_mfma_f32_32x32x16_bf16 v[44:59], a[108:111], v[112:115], v[44:59]
    v_mfma_f32_32x32x16_bf16 v[44:59], a[120:123], v[116:119], v[44:59]
    v_mfma_f32_32x32x16_bf16 v[44:59], a[124:127], v[120:123], v[44:59]
L_OR15:
    buffer_load_dwordx4 v[76:79], v6, s[28:31], s70 offen offset:2048 sc1
    buffer_load_dwordx4 v[80:83], v6, s[28:31], s70 offen offset:3072 sc1
    buffer_load_dwordx4 v[84:87], v6, s[28:31], s71 offen offset:2048 sc1
    buffer_load_dwordx4 v[88:91], v6, s[28:31], s71 offen offset:3072 sc1
    s_waitcnt vmcnt(3)
    v_max3_u32 v4, v76, v77, v78
    s_waitcnt vmcnt(2)
    v_max3_u32 v4, v4, v79, v80
    v_max3_u32 v4, v4, v81, v82
    s_waitcnt vmcnt(1)
    v_max3_u32 v4, v4, v83, v84
    v_max3_u32 v4, v4, v85, v86
    s_waitcnt vmcnt(0)
    v_max3_u32 v4, v4, v87, v88
    v_max3_u32 v4, v4, v89, v90
    v_max_u32 v4, v4, v91
    v_cmp_eq_u32 vcc, -1, v4
    s_sub_u32 s55, s55, 1
    s_cbranch_scc1 L_OG15
    s_nop 2
    s_cbranch_vccnz L_OR15
L_OG15:
    v_mfma_f32_32x32x16_bf16 v[60:75], a[104:107], v[76:79], v[60:75]
    v_mfma_f32_32x32x16_bf16 v[60:75], a[108:111], v[80:83], v[60:75]
    v_mfma_f32_32x32x16_bf16 v[60:75], a[120:123], v[84:87], v[60:75]
    v_mfma_f32_32x32x16_bf16 v[60:75], a[124:127], v[88:91], v[60:75]
    s_nop 11
    s_branch L_OOK
L_END:
    s_endpgm
.section .rodata,"a"
.p2align 6
.amdhsa_kernel concat_heads__linear_kernel_hedgehog__linear_kernel_hedgehog__prompt_kernel
  .amdhsa_next_free_vgpr 256
  .amdhsa_next_free_sgpr 102
  .amdhsa_accum_offset 128
  .amdhsa_group_segment_fixed_size 0
  .amdhsa_kernarg_size 88
  .amdhsa_user_sgpr_count 2
  .amdhsa_user_sgpr_kernarg_segment_ptr 1
  .amdhsa_system_sgpr_workgroup_id_x 1
.end_amdhsa_kernel
```
